```python
import torch

def _softmax(x, axis=-1):
    return torch.softmax(x, dim=axis)
def _gelu(x):
    return torch.nn.functional.gelu(x, approximate="tanh")
def _silu(x):
    return torch.nn.functional.silu(x)
def _sigmoid(x):
    return torch.sigmoid(x)
def _layernorm(x, axis=-1, eps=1e-5):
    m = x.mean(dim=axis, keepdim=True)
    v = x.var(dim=axis, keepdim=True, unbiased=False)
    return (x - m) / torch.sqrt(v + eps)
def _scatter_add(tgt, idx, src, axis=0):
    return tgt.clone().index_add_(axis, idx, src)
def _segment_sum(src, seg, n):
    out = torch.zeros((n,) + src.shape[1:], dtype=src.dtype)
    return out.index_add_(0, seg, src)
def _pad(x, pw):
    flat = tuple(v for pair in reversed(pw) for v in pair)
    return torch.nn.functional.pad(x, flat)

kernel_name = 'recurrent_scan__ssm_conv_s4d__mixer_channel_mlp__prompt'

def setup_inputs():

    _w = (lambda a: (lambda t: t.to(torch.bfloat16) if t.is_floating_point() else t)(torch.as_tensor(a)))
    def _A_setup():
        Bsz, L, D, N = 1, 2048, 448, 256
        return {
            "u": _w((lambda *s: torch.randn(*s, dtype=torch.bfloat16) * 0.05)(Bsz, L, D)),
            "log_A_real": _w((lambda *s: torch.randn(*s, dtype=torch.bfloat16) * 3.2)(D, N) * 0.5),
            "A_imag": _w((lambda *s: torch.randn(*s, dtype=torch.bfloat16) * 0.2)(D, N) * 3.14),
            "C_real": _w((lambda *s: torch.randn(*s, dtype=torch.bfloat16) * 0.8)(D, N) / N ** 0.5),
            "C_imag": _w((lambda *s: torch.randn(*s, dtype=torch.bfloat16) * 0.8)(D, N) / N ** 0.5),
            "log_dt": _w((lambda *s: torch.randn(*s, dtype=torch.bfloat16) * 0.2)(D) * 0.5 - 4.0),
            "D_skip": _w((lambda *s: torch.randn(*s, dtype=torch.bfloat16) * 0.2)(D)),
        }
    _A_in = _A_setup()

    def _B_setup():
        B, S, D, F = 1, 2048, 448, 1792
        return {
            "x": _w((lambda *s: torch.randn(*s, dtype=torch.bfloat16) * 0.05)(B, S, D)),
            "w1": _w((lambda *s: torch.randn(*s, dtype=torch.bfloat16) * 1.6)(D, F) * (D ** -0.5)),
            "b1": _w((lambda *s: torch.randn(*s, dtype=torch.bfloat16) * 0.8)(F)),
            "w2": _w((lambda *s: torch.randn(*s, dtype=torch.bfloat16) * 0.1)(F, D) * (F ** -0.5)),
            "b2": _w((lambda *s: torch.randn(*s, dtype=torch.bfloat16) * 0.1)(D)),
        }
    _B_in = _B_setup()

    return {
        "A_u": _A_in["u"],
        "A_log_A_real": _A_in["log_A_real"],
        "A_A_imag": _A_in["A_imag"],
        "A_C_real": _A_in["C_real"],
        "A_C_imag": _A_in["C_imag"],
        "A_log_dt": _A_in["log_dt"],
        "A_D_skip": _A_in["D_skip"],
        "B_x": _B_in["x"],
        "B_w1": _B_in["w1"],
        "B_b1": _B_in["b1"],
        "B_w2": _B_in["w2"],
        "B_b2": _B_in["b2"],
    }

def reference(A_u, A_log_A_real, A_A_imag, A_C_real, A_C_imag, A_log_dt, A_D_skip, B_x, B_w1, B_b1, B_w2, B_b2):
    def _A_ref(u, log_A_real, A_imag, C_real, C_imag, log_dt, D_skip):
        L = u.shape[1]
        dt = torch.exp(log_dt)
        A = -torch.exp(log_A_real) + 1j * A_imag
        C = (C_real + 1j * C_imag) * dt[:, None]
        pos = (lambda x, dt: x.to(dt))(torch.arange(L), log_dt.dtype)
        P = torch.exp((A * dt[:, None])[:, :, None] * pos[None, None, :])
        K = 2.0 * torch.einsum("dn,dnl->dl", C, P).real
        L2 = 2 * L
        u_t = (lambda x, *d: x.permute(*d))(u, 0, 2, 1)
        Kf = (lambda x, *a, **k: torch.fft.rfft(x.float(), *a, **k))(K, L2)
        Uf = (lambda x, *a, **k: torch.fft.rfft(x.float(), *a, **k))(u_t, L2)
        y = (lambda x, *a, **k: torch.fft.irfft(x, *a, **k).to(torch.bfloat16))(Uf * Kf[None, :, :], L2)[:, :, :L]
        y = (lambda x, *d: x.permute(*d))(y, 0, 2, 1)
        return y + u * D_skip[None, None, :]

    def _B_ref(x, w1, b1, w2, b2):
        y = _layernorm(x, axis=-1)
        h = _gelu(torch.einsum("bsd,df->bsf", y, w1) + b1)
        return torch.einsum("bsf,fd->bsd", h, w2) + b2

    x = A_u
    xn = _layernorm(x, axis=-1)
    s = _A_ref(xn, A_log_A_real, A_A_imag, A_C_real, A_C_imag, A_log_dt, A_D_skip)
    g = _silu(_B_ref(xn, B_w1, B_b1, B_w2, B_b2))
    return x + s * g
```

```asm
; @launch grid=(512,1,1) block=(256,1,1) lds=81920
.amdgcn_target "amdgcn-amd-amdhsa--gfx950"
.text
.globl recurrent_scan__ssm_conv_s4d__mixer_channel_mlp__prompt_kernel
.p2align 8
.type recurrent_scan__ssm_conv_s4d__mixer_channel_mlp__prompt_kernel,@function
recurrent_scan__ssm_conv_s4d__mixer_channel_mlp__prompt_kernel:
    s_cmp_ge_u32 s2, 512
    s_cbranch_scc1 K_EXIT
    s_cmp_ge_u32 s2, 288
    s_cbranch_scc1 K_SSM
    s_sub_u32 s3, s2, 32
    s_cmp_lt_u32 s3, 224
    s_cbranch_scc1 K_MLP
    s_sub_u32 s4, s2, 224
    s_cmp_lt_u32 s2, 32
    s_cselect_b32 s3, s2, s4
    s_and_b32 s4, s3, 7
    s_lshl_b32 s4, s4, 3
    s_lshr_b32 s3, s3, 3
    s_add_u32 s3, s3, s4
    s_load_dwordx2 s[4:5], s[0:1], 0
    s_load_dwordx2 s[8:9], s[0:1], 112
    s_load_dwordx2 s[12:13], s[0:1], 104
    s_memrealtime s[26:27]
    v_and_b32 v1, 63, v0
    v_lshrrev_b32 v2, 6, v0
    s_nop 0
    v_readfirstlane_b32 s20, v2
    v_lshrrev_b32 v2, 3, v0
    v_mul_u32_u24 v4, 896, v2
    v_and_b32 v3, 7, v0
    v_lshl_add_u32 v4, v3, 4, v4
    s_mul_i32 s21, s3, 28672
    s_waitcnt lgkmcnt(0)
    s_mov_b32 s6, 1835008
    s_mov_b32 s7, 0x00020000
    s_mov_b32 s10, 14680064
    s_mov_b32 s11, 0x00020000
    s_mov_b32 s14, 256
    s_mov_b32 s15, 0x00020000
    buffer_load_dwordx4 v[8:11], v4, s[4:7], s21 offen offset:0
    buffer_load_dwordx4 v[12:15], v4, s[4:7], s21 offen offset:128
    buffer_load_dwordx4 v[16:19], v4, s[4:7], s21 offen offset:256
    buffer_load_dwordx4 v[20:23], v4, s[4:7], s21 offen offset:384
    buffer_load_dwordx4 v[24:27], v4, s[4:7], s21 offen offset:512
    buffer_load_dwordx4 v[28:31], v4, s[4:7], s21 offen offset:640
    buffer_load_dwordx4 v[32:35], v4, s[4:7], s21 offen offset:768
    s_or_b32 s24, s26, 1
    v_mov_b32 v36, s24
    v_mov_b32 v37, 0
    s_cmp_lg_u32 s20, 0
    s_cbranch_scc1 PREP_NW_1
    ds_write_b32 v37, v36 offset:32768
    s_lshl_b32 s22, s3, 2
    s_mov_b64 s[28:29], exec
    s_mov_b64 exec, 1
    buffer_store_dword v36, v37, s[12:15], s22 offen sc1
    s_mov_b64 exec, s[28:29]
    s_waitcnt lgkmcnt(0)
PREP_NW_1:
    s_barrier
    ds_read_b32 v36, v37 offset:32768
    v_mov_b32 v42, 0x3f803f80
    v_mov_b32 v38, 0
    v_mov_b32 v39, 0
    v_mov_b32 v40, 0
    v_mov_b32 v41, 0
    s_cmp_eq_u32 s20, 0
    s_cbranch_scc1 PREP_W0_2
    s_waitcnt vmcnt(0)
    s_branch PREP_W1_3
PREP_W0_2:
    s_waitcnt vmcnt(1)
PREP_W1_3:
    v_dot2c_f32_bf16 v38, v8, v42
    v_dot2c_f32_bf16 v39, v8, v8
    v_dot2c_f32_bf16 v40, v9, v42
    v_dot2c_f32_bf16 v41, v9, v9
    v_dot2c_f32_bf16 v38, v10, v42
    v_dot2c_f32_bf16 v39, v10, v10
    v_dot2c_f32_bf16 v40, v11, v42
    v_dot2c_f32_bf16 v41, v11, v11
    v_dot2c_f32_bf16 v38, v12, v42
    v_dot2c_f32_bf16 v39, v12, v12
    v_dot2c_f32_bf16 v40, v13, v42
    v_dot2c_f32_bf16 v41, v13, v13
    v_dot2c_f32_bf16 v38, v14, v42
    v_dot2c_f32_bf16 v39, v14, v14
    v_dot2c_f32_bf16 v40, v15, v42
    v_dot2c_f32_bf16 v41, v15, v15
    v_dot2c_f32_bf16 v38, v16, v42
    v_dot2c_f32_bf16 v39, v16, v16
    v_dot2c_f32_bf16 v40, v17, v42
    v_dot2c_f32_bf16 v41, v17, v17
    v_dot2c_f32_bf16 v38, v18, v42
    v_dot2c_f32_bf16 v39, v18, v18
    v_dot2c_f32_bf16 v40, v19, v42
    v_dot2c_f32_bf16 v41, v19, v19
    v_dot2c_f32_bf16 v38, v20, v42
    v_dot2c_f32_bf16 v39, v20, v20
    v_dot2c_f32_bf16 v40, v21, v42
    v_dot2c_f32_bf16 v41, v21, v21
    v_dot2c_f32_bf16 v38, v22, v42
    v_dot2c_f32_bf16 v39, v22, v22
    v_dot2c_f32_bf16 v40, v23, v42
    v_dot2c_f32_bf16 v41, v23, v23
    v_dot2c_f32_bf16 v38, v24, v42
    v_dot2c_f32_bf16 v39, v24, v24
    v_dot2c_f32_bf16 v40, v25, v42
    v_dot2c_f32_bf16 v41, v25, v25
    v_dot2c_f32_bf16 v38, v26, v42
    v_dot2c_f32_bf16 v39, v26, v26
    v_dot2c_f32_bf16 v40, v27, v42
    v_dot2c_f32_bf16 v41, v27, v27
    v_dot2c_f32_bf16 v38, v28, v42
    v_dot2c_f32_bf16 v39, v28, v28
    v_dot2c_f32_bf16 v40, v29, v42
    v_dot2c_f32_bf16 v41, v29, v29
    v_dot2c_f32_bf16 v38, v30, v42
    v_dot2c_f32_bf16 v39, v30, v30
    v_dot2c_f32_bf16 v40, v31, v42
    v_dot2c_f32_bf16 v41, v31, v31
    v_dot2c_f32_bf16 v38, v32, v42
    v_dot2c_f32_bf16 v39, v32, v32
    v_dot2c_f32_bf16 v40, v33, v42
    v_dot2c_f32_bf16 v41, v33, v33
    v_dot2c_f32_bf16 v38, v34, v42
    v_dot2c_f32_bf16 v39, v34, v34
    v_dot2c_f32_bf16 v40, v35, v42
    v_dot2c_f32_bf16 v41, v35, v35
    s_nop 1
    v_add_f32 v38, v38, v40
    s_nop 1
    v_add_f32 v39, v39, v41
    s_nop 0
    v_add_f32_dpp v38, v38, v38 quad_perm:[1,0,3,2] row_mask:0xf bank_mask:0xf
    s_nop 0
    v_add_f32_dpp v39, v39, v39 quad_perm:[1,0,3,2] row_mask:0xf bank_mask:0xf
    s_nop 0
    v_add_f32_dpp v38, v38, v38 quad_perm:[2,3,0,1] row_mask:0xf bank_mask:0xf
    s_nop 0
    v_add_f32_dpp v39, v39, v39 quad_perm:[2,3,0,1] row_mask:0xf bank_mask:0xf
    s_nop 0
    v_add_f32_dpp v38, v38, v38 row_half_mirror row_mask:0xf bank_mask:0xf
    s_nop 0
    v_add_f32_dpp v39, v39, v39 row_half_mirror row_mask:0xf bank_mask:0xf
    v_mul_f32 v43, 0x3b124925, v38
    v_mul_f32 v44, 0x3b124925, v39
    v_fma_f32 v44, -v43, v43, v44
    v_max_f32 v44, 0, v44
    v_cvt_pk_bf16_f32 v45, v43, v43
    v_and_b32 v45, 0xffff0000, v45
    v_cvt_pk_bf16_f32 v49, v44, v44
    v_and_b32 v49, 0xffff0000, v49
    v_add_f32 v49, 0x3727c5ac, v49
    v_cvt_pk_bf16_f32 v49, v49, v49
    v_and_b32 v49, 0xffff0000, v49
    v_sqrt_f32 v49, v49
    s_nop 0
    v_cvt_pk_bf16_f32 v46, v49, v49
    v_and_b32 v46, 0xffff0000, v46
    v_rcp_f32 v50, v46
    v_sub_f32 v47, v43, v45
    v_mul_f32 v52, v45, v50
    v_sub_f32 v52, 0, v52
    v_mul_f32 v47, v47, v50
    v_mul_f32 v49, v44, v50
    v_mul_f32 v49, v49, v50
    v_cvt_pk_bf16_f32 v47, v47, v47
    v_and_b32 v47, 0xffff0000, v47
    v_cvt_pk_bf16_f32 v49, v49, v49
    v_and_b32 v49, 0xffff0000, v49
    v_add_f32 v49, 0x3727c5ac, v49
    v_cvt_pk_bf16_f32 v49, v49, v49
    v_and_b32 v49, 0xffff0000, v49
    v_sqrt_f32 v49, v49
    s_nop 0
    v_cvt_pk_bf16_f32 v48, v49, v49
    v_and_b32 v48, 0xffff0000, v48
    v_mul_f32 v64, v46, v48
    v_rcp_f32 v65, v64
    v_fma_f32 v66, v47, v46, v45
    v_sub_f32 v66, 0, v66
    v_cvt_pk_bf16_f32 v56, v66, v66
    v_and_b32 v49, 0xffff0000, v56
    v_sub_f32 v49, v66, v49
    v_cvt_pk_bf16_f32 v57, v49, v64
    v_and_b32 v49, 0xffff0000, v57
    v_sub_f32 v49, v64, v49
    v_cvt_pk_bf16_f32 v58, v49, v37
    v_mul_f32 v60, 0xc0135761, v65
    v_mul_f32 v49, v65, v65
    v_mul_f32 v49, v49, v65
    v_mul_f32 v61, 0xbdd2d3e8, v49
    v_mov_b32 v62, v64
    s_waitcnt lgkmcnt(0)
    v_mov_b32 v59, v36
    v_mov_b32 v63, v36
    v_cmp_eq_u32 vcc, 1, v3
    s_nop 1
    v_cndmask_b32 v56, v56, v60, vcc
    s_nop 0
    v_cndmask_b32 v57, v57, v61, vcc
    v_cndmask_b32 v58, v58, v62, vcc
    v_cndmask_b32 v59, v59, v63, vcc
    v_lshlrev_b32 v67, 5, v2
    v_lshl_add_u32 v67, v3, 4, v67
    s_lshl_b32 s21, s3, 10
    s_add_u32 s21, s21, 1900544
    v_cmp_gt_u32 vcc, 2, v3
    s_and_saveexec_b64 s[28:29], vcc
    buffer_store_dwordx4 v[56:59], v67, s[8:11], s21 offen sc1
    s_mov_b64 exec, s[28:29]
    s_cmp_ge_u32 s3, 7
    s_cbranch_scc1 PREP_NP_4
    v_mov_b32 v68, 0
    v_mov_b32 v69, 0
    v_mov_b32 v70, 0
    v_mov_b32 v71, 0
    v_lshrrev_b32 v72, 1, v1
    v_mul_u32_u24 v72, 4224, v72
    v_and_b32 v49, 1, v1
    v_lshl_add_u32 v72, v49, 4, v72
    s_lshl_b32 s21, s3, 2
    s_add_u32 s21, s21, s20
    s_mul_i32 s21, s21, 67584
    s_add_u32 s21, s21, 96
    v_cmp_gt_u32 vcc, 32, v1
    s_and_saveexec_b64 s[28:29], vcc
    buffer_store_dwordx4 v[68:71], v72, s[8:11], s21 offen sc1
    s_mov_b64 exec, s[28:29]
PREP_NP_4:
    v_mul_u32_u24 v82, 912, v2
    v_lshl_add_u32 v82, v3, 4, v82
    v_lshlrev_b32 v74, 16, v8
    v_and_b32 v75, 0xffff0000, v8
    v_lshlrev_b32 v76, 16, v9
    v_and_b32 v77, 0xffff0000, v9
    v_lshlrev_b32 v78, 16, v10
    v_and_b32 v79, 0xffff0000, v10
    v_lshlrev_b32 v80, 16, v11
    v_and_b32 v81, 0xffff0000, v11
    v_pk_fma_f32 v[74:75], v[74:75], v[50:51], v[52:53] op_sel_hi:[1,0,0]
    v_pk_fma_f32 v[76:77], v[76:77], v[50:51], v[52:53] op_sel_hi:[1,0,0]
    v_pk_fma_f32 v[78:79], v[78:79], v[50:51], v[52:53] op_sel_hi:[1,0,0]
    v_pk_fma_f32 v[80:81], v[80:81], v[50:51], v[52:53] op_sel_hi:[1,0,0]
    v_cvt_pk_bf16_f32 v8, v74, v75
    v_cvt_pk_bf16_f32 v9, v76, v77
    v_cvt_pk_bf16_f32 v10, v78, v79
    v_cvt_pk_bf16_f32 v11, v80, v81
    ds_write_b128 v82, v[8:11] offset:0
    v_lshlrev_b32 v74, 16, v12
    v_and_b32 v75, 0xffff0000, v12
    v_lshlrev_b32 v76, 16, v13
    v_and_b32 v77, 0xffff0000, v13
    v_lshlrev_b32 v78, 16, v14
    v_and_b32 v79, 0xffff0000, v14
    v_lshlrev_b32 v80, 16, v15
    v_and_b32 v81, 0xffff0000, v15
    v_pk_fma_f32 v[74:75], v[74:75], v[50:51], v[52:53] op_sel_hi:[1,0,0]
    v_pk_fma_f32 v[76:77], v[76:77], v[50:51], v[52:53] op_sel_hi:[1,0,0]
    v_pk_fma_f32 v[78:79], v[78:79], v[50:51], v[52:53] op_sel_hi:[1,0,0]
    v_pk_fma_f32 v[80:81], v[80:81], v[50:51], v[52:53] op_sel_hi:[1,0,0]
    v_cvt_pk_bf16_f32 v12, v74, v75
    v_cvt_pk_bf16_f32 v13, v76, v77
    v_cvt_pk_bf16_f32 v14, v78, v79
    v_cvt_pk_bf16_f32 v15, v80, v81
    ds_write_b128 v82, v[12:15] offset:128
    v_lshlrev_b32 v74, 16, v16
    v_and_b32 v75, 0xffff0000, v16
    v_lshlrev_b32 v76, 16, v17
    v_and_b32 v77, 0xffff0000, v17
    v_lshlrev_b32 v78, 16, v18
    v_and_b32 v79, 0xffff0000, v18
    v_lshlrev_b32 v80, 16, v19
    v_and_b32 v81, 0xffff0000, v19
    v_pk_fma_f32 v[74:75], v[74:75], v[50:51], v[52:53] op_sel_hi:[1,0,0]
    v_pk_fma_f32 v[76:77], v[76:77], v[50:51], v[52:53] op_sel_hi:[1,0,0]
    v_pk_fma_f32 v[78:79], v[78:79], v[50:51], v[52:53] op_sel_hi:[1,0,0]
    v_pk_fma_f32 v[80:81], v[80:81], v[50:51], v[52:53] op_sel_hi:[1,0,0]
    v_cvt_pk_bf16_f32 v16, v74, v75
    v_cvt_pk_bf16_f32 v17, v76, v77
    v_cvt_pk_bf16_f32 v18, v78, v79
    v_cvt_pk_bf16_f32 v19, v80, v81
    ds_write_b128 v82, v[16:19] offset:256
    v_lshlrev_b32 v74, 16, v20
    v_and_b32 v75, 0xffff0000, v20
    v_lshlrev_b32 v76, 16, v21
    v_and_b32 v77, 0xffff0000, v21
    v_lshlrev_b32 v78, 16, v22
    v_and_b32 v79, 0xffff0000, v22
    v_lshlrev_b32 v80, 16, v23
    v_and_b32 v81, 0xffff0000, v23
    v_pk_fma_f32 v[74:75], v[74:75], v[50:51], v[52:53] op_sel_hi:[1,0,0]
    v_pk_fma_f32 v[76:77], v[76:77], v[50:51], v[52:53] op_sel_hi:[1,0,0]
    v_pk_fma_f32 v[78:79], v[78:79], v[50:51], v[52:53] op_sel_hi:[1,0,0]
    v_pk_fma_f32 v[80:81], v[80:81], v[50:51], v[52:53] op_sel_hi:[1,0,0]
    v_cvt_pk_bf16_f32 v20, v74, v75
    v_cvt_pk_bf16_f32 v21, v76, v77
    v_cvt_pk_bf16_f32 v22, v78, v79
    v_cvt_pk_bf16_f32 v23, v80, v81
    ds_write_b128 v82, v[20:23] offset:384
    v_lshlrev_b32 v74, 16, v24
    v_and_b32 v75, 0xffff0000, v24
    v_lshlrev_b32 v76, 16, v25
    v_and_b32 v77, 0xffff0000, v25
    v_lshlrev_b32 v78, 16, v26
    v_and_b32 v79, 0xffff0000, v26
    v_lshlrev_b32 v80, 16, v27
    v_and_b32 v81, 0xffff0000, v27
    v_pk_fma_f32 v[74:75], v[74:75], v[50:51], v[52:53] op_sel_hi:[1,0,0]
    v_pk_fma_f32 v[76:77], v[76:77], v[50:51], v[52:53] op_sel_hi:[1,0,0]
    v_pk_fma_f32 v[78:79], v[78:79], v[50:51], v[52:53] op_sel_hi:[1,0,0]
    v_pk_fma_f32 v[80:81], v[80:81], v[50:51], v[52:53] op_sel_hi:[1,0,0]
    v_cvt_pk_bf16_f32 v24, v74, v75
    v_cvt_pk_bf16_f32 v25, v76, v77
    v_cvt_pk_bf16_f32 v26, v78, v79
    v_cvt_pk_bf16_f32 v27, v80, v81
    ds_write_b128 v82, v[24:27] offset:512
    v_lshlrev_b32 v74, 16, v28
    v_and_b32 v75, 0xffff0000, v28
    v_lshlrev_b32 v76, 16, v29
    v_and_b32 v77, 0xffff0000, v29
    v_lshlrev_b32 v78, 16, v30
    v_and_b32 v79, 0xffff0000, v30
    v_lshlrev_b32 v80, 16, v31
    v_and_b32 v81, 0xffff0000, v31
    v_pk_fma_f32 v[74:75], v[74:75], v[50:51], v[52:53] op_sel_hi:[1,0,0]
    v_pk_fma_f32 v[76:77], v[76:77], v[50:51], v[52:53] op_sel_hi:[1,0,0]
    v_pk_fma_f32 v[78:79], v[78:79], v[50:51], v[52:53] op_sel_hi:[1,0,0]
    v_pk_fma_f32 v[80:81], v[80:81], v[50:51], v[52:53] op_sel_hi:[1,0,0]
    v_cvt_pk_bf16_f32 v28, v74, v75
    v_cvt_pk_bf16_f32 v29, v76, v77
    v_cvt_pk_bf16_f32 v30, v78, v79
    v_cvt_pk_bf16_f32 v31, v80, v81
    ds_write_b128 v82, v[28:31] offset:640
    v_lshlrev_b32 v74, 16, v32
    v_and_b32 v75, 0xffff0000, v32
    v_lshlrev_b32 v76, 16, v33
    v_and_b32 v77, 0xffff0000, v33
    v_lshlrev_b32 v78, 16, v34
    v_and_b32 v79, 0xffff0000, v34
    v_lshlrev_b32 v80, 16, v35
    v_and_b32 v81, 0xffff0000, v35
    v_pk_fma_f32 v[74:75], v[74:75], v[50:51], v[52:53] op_sel_hi:[1,0,0]
    v_pk_fma_f32 v[76:77], v[76:77], v[50:51], v[52:53] op_sel_hi:[1,0,0]
    v_pk_fma_f32 v[78:79], v[78:79], v[50:51], v[52:53] op_sel_hi:[1,0,0]
    v_pk_fma_f32 v[80:81], v[80:81], v[50:51], v[52:53] op_sel_hi:[1,0,0]
    v_cvt_pk_bf16_f32 v32, v74, v75
    v_cvt_pk_bf16_f32 v33, v76, v77
    v_cvt_pk_bf16_f32 v34, v78, v79
    v_cvt_pk_bf16_f32 v35, v80, v81
    ds_write_b128 v82, v[32:35] offset:768
    v_lshrrev_b32 v83, 4, v1
    v_bfe_u32 v84, v1, 2, 2
    v_and_b32 v85, 3, v1
    v_lshl_add_u32 v86, v85, 3, v84
    v_mul_u32_u24 v86, 912, v86
    v_lshl_add_u32 v86, v83, 3, v86
    s_lshl_b32 s21, s20, 5
    v_add_u32 v86, s21, v86
    v_lshl_add_u32 v87, v83, 2, v85
    v_mul_u32_u24 v87, 4224, v87
    v_lshl_add_u32 v87, v84, 4, v87
    s_mul_i32 s21, s20, 67584
    s_lshl_b32 s22, s3, 6
    s_add_u32 s21, s21, s22
    s_add_u32 s21, s21, 128
    s_waitcnt lgkmcnt(0)
    s_barrier
    ds_read_b64_tr_b16 v[88:89], v86 offset:0
    ds_read_b64_tr_b16 v[90:91], v86 offset:3648
    ds_read_b64_tr_b16 v[92:93], v86 offset:128
    ds_read_b64_tr_b16 v[94:95], v86 offset:3776
    ds_read_b64_tr_b16 v[96:97], v86 offset:256
    ds_read_b64_tr_b16 v[98:99], v86 offset:3904
    ds_read_b64_tr_b16 v[100:101], v86 offset:384
    ds_read_b64_tr_b16 v[102:103], v86 offset:4032
    ds_read_b64_tr_b16 v[104:105], v86 offset:512
    ds_read_b64_tr_b16 v[106:107], v86 offset:4160
    ds_read_b64_tr_b16 v[108:109], v86 offset:640
    ds_read_b64_tr_b16 v[110:111], v86 offset:4288
    ds_read_b64_tr_b16 v[112:113], v86 offset:768
    ds_read_b64_tr_b16 v[114:115], v86 offset:4416
    s_waitcnt lgkmcnt(12)
    buffer_store_dwordx4 v[88:91], v87, s[8:11], s21 offen sc1
    s_add_u32 s21, s21, 270336
    s_waitcnt lgkmcnt(10)
    buffer_store_dwordx4 v[92:95], v87, s[8:11], s21 offen sc1
    s_add_u32 s21, s21, 270336
    s_waitcnt lgkmcnt(8)
    buffer_store_dwordx4 v[96:99], v87, s[8:11], s21 offen sc1
    s_add_u32 s21, s21, 270336
    s_waitcnt lgkmcnt(6)
    buffer_store_dwordx4 v[100:103], v87, s[8:11], s21 offen sc1
    s_add_u32 s21, s21, 270336
    s_waitcnt lgkmcnt(4)
    buffer_store_dwordx4 v[104:107], v87, s[8:11], s21 offen sc1
    s_add_u32 s21, s21, 270336
    s_waitcnt lgkmcnt(2)
    buffer_store_dwordx4 v[108:111], v87, s[8:11], s21 offen sc1
    s_add_u32 s21, s21, 270336
    s_waitcnt lgkmcnt(0)
    buffer_store_dwordx4 v[112:115], v87, s[8:11], s21 offen sc1
    s_lshl_b32 s21, s20, 8
    s_lshl_b32 s22, s3, 2
    s_add_u32 s21, s21, s22
    s_add_u32 s21, s21, 1966080
    v_mul_u32_u24 v37, 4352, v1
    s_waitcnt vmcnt(0)
    s_mov_b64 exec, 0x7f
    buffer_store_dword v36, v37, s[8:11], s21 offen sc1
    s_mov_b64 exec, -1
    s_endpgm
K_SSM:
    s_sub_u32 s3, s2, 288
    s_load_dwordx2 s[4:5], s[0:1], 8
    s_load_dwordx2 s[8:9], s[0:1], 16
    s_load_dwordx2 s[12:13], s[0:1], 24
    s_load_dwordx2 s[16:17], s[0:1], 32
    s_load_dwordx2 s[20:21], s[0:1], 112
    s_load_dwordx2 s[24:25], s[0:1], 40
    s_load_dwordx2 s[26:27], s[0:1], 48
    s_load_dwordx2 s[44:45], s[0:1], 104
    s_setprio 3
    v_and_b32 v1, 63, v0
    v_lshrrev_b32 v2, 6, v0
    s_nop 0
    v_readfirstlane_b32 s32, v2
    s_lshr_b32 s33, s32, 1
    s_and_b32 s34, s32, 1
    s_lshl_b32 s35, s3, 1
    s_add_u32 s35, s35, s33
    v_lshlrev_b32 v5, 2, v1
    s_lshl_b32 s36, s35, 9
    s_lshl_b32 s37, s34, 8
    s_add_u32 s36, s36, s37
    s_lshl_b32 s38, s3, 2
    s_waitcnt lgkmcnt(0)
    s_mov_b32 s6, 229376
    s_mov_b32 s7, 0x00020000
    s_mov_b32 s10, 229376
    s_mov_b32 s11, 0x00020000
    s_mov_b32 s14, 229376
    s_mov_b32 s15, 0x00020000
    s_mov_b32 s18, 229376
    s_mov_b32 s19, 0x00020000
    s_mov_b32 s22, 14680064
    s_mov_b32 s23, 0x00020000
    s_mov_b32 s46, 256
    s_mov_b32 s47, 0x00020000
    buffer_load_dword v6, v5, s[4:7], s36 offen
    buffer_load_dword v7, v5, s[8:11], s36 offen
    buffer_load_dword v8, v5, s[12:15], s36 offen
    buffer_load_dword v9, v5, s[16:19], s36 offen
    s_load_dword s39, s[24:25], s38
    s_load_dword s40, s[26:27], s38
    v_mov_b32 v10, 0
    v_mov_b32 v11, 0
    v_lshlrev_b32 v3, 3, v1
    s_mul_i32 s36, s33, 4608
    v_add_u32 v3, s36, v3
    ds_write_b64 v3, v[10:11] offset:38912
    v_lshlrev_b32 v3, 3, v1
    s_mul_i32 s36, s33, 17408
    v_add_u32 v3, s36, v3
    s_mov_b64 exec, 0xff
    ds_write_b64 v3, v[10:11] offset:0
    s_mov_b64 exec, -1
    s_lshl_b32 s36, s34, 6
    v_add_u32 v28, s36, v1
    v_lshlrev_b32 v2, 1, v28
    v_sub_u32 v2, 2047, v2
    v_cvt_f32_u32 v30, v2
    v_add_f32 v31, -1.0, v30
    s_mul_i32 s36, s33, 3072
    s_add_u32 s36, s36, 44032
    s_sub_u32 s37, s36, 68096
    v_mov_b32 v32, 0xc3800000
    v_mov_b32 v33, 0xc3800000
    v_cvt_pk_bf16_f32 v3, v30, v31
    v_and_b32 v4, 0xffff, v3
    v_lshl_add_u32 v12, v4, 2, s37
    v_lshrrev_b32 v4, 16, v3
    v_lshl_add_u32 v13, v4, 2, s37
    v_pk_add_f32 v[30:31], v[30:31], v[32:33]
    v_cvt_pk_bf16_f32 v3, v30, v31
    v_and_b32 v4, 0xffff, v3
    v_lshl_add_u32 v14, v4, 2, s37
    v_lshrrev_b32 v4, 16, v3
    v_lshl_add_u32 v15, v4, 2, s37
    v_pk_add_f32 v[30:31], v[30:31], v[32:33]
    v_cvt_pk_bf16_f32 v3, v30, v31
    v_and_b32 v4, 0xffff, v3
    v_lshl_add_u32 v16, v4, 2, s37
    v_lshrrev_b32 v4, 16, v3
    v_lshl_add_u32 v17, v4, 2, s37
    v_pk_add_f32 v[30:31], v[30:31], v[32:33]
    v_cvt_pk_bf16_f32 v3, v30, v31
    v_and_b32 v4, 0xffff, v3
    v_lshl_add_u32 v18, v4, 2, s37
    v_lshrrev_b32 v4, 16, v3
    v_lshl_add_u32 v19, v4, 2, s37
    v_pk_add_f32 v[30:31], v[30:31], v[32:33]
    v_cvt_pk_bf16_f32 v3, v30, v31
    v_and_b32 v4, 0xffff, v3
    v_lshl_add_u32 v20, v4, 2, s37
    v_lshrrev_b32 v4, 16, v3
    v_lshl_add_u32 v21, v4, 2, s37
    v_pk_add_f32 v[30:31], v[30:31], v[32:33]
    v_cvt_pk_bf16_f32 v3, v30, v31
    v_and_b32 v4, 0xffff, v3
    v_lshl_add_u32 v22, v4, 2, s37
    v_lshrrev_b32 v4, 16, v3
    v_lshl_add_u32 v23, v4, 2, s37
    v_pk_add_f32 v[30:31], v[30:31], v[32:33]
    v_cvt_pk_bf16_f32 v3, v30, v31
    v_and_b32 v4, 0xffff, v3
    v_lshl_add_u32 v24, v4, 2, s37
    v_lshrrev_b32 v4, 16, v3
    v_lshl_add_u32 v25, v4, 2, s37
    v_subrev_u32 v2, 1792, v2
    v_lshl_add_u32 v26, v2, 2, s36
    v_add_u32 v27, -4, v26
    s_mul_i32 s36, s32, 4352
    s_add_u32 s36, s36, 50176
    v_lshrrev_b32 v2, 4, v1
    v_mul_u32_u24 v34, 1088, v2
    v_bfe_u32 v3, v1, 2, 2
    v_mul_u32_u24 v3, 272, v3
    v_add_u32 v34, v34, v3
    v_and_b32 v3, 3, v1
    v_lshl_add_u32 v34, v3, 2, v34
    v_add_u32 v34, s36, v34
    v_mul_u32_u24 v35, 272, v2
    v_and_b32 v3, 15, v1
    v_lshl_add_u32 v35, v3, 4, v35
    v_add_u32 v35, s36, v35
    s_mul_i32 s36, s33, 3072
    s_add_u32 s36, s36, 44032
    v_lshrrev_b32 v4, 1, v2
    v_lshlrev_b32 v36, 7, v4
    v_lshl_add_u32 v36, v3, 3, v36
    v_and_b32 v37, 1, v2
    v_lshl_add_u32 v36, v37, 2, v36
    v_lshl_add_u32 v36, v36, 2, s36
    v_lshlrev_b32 v37, 1, v3
    v_lshlrev_b32 v38, 2, v3
    v_cmp_gt_u32 vcc, 2, v2
    s_nop 1
    v_cndmask_b32 v37, v37, v38, vcc
    v_lshl_add_u32 v37, v2, 6, v37
    v_add_u32 v37, 256, v37
    v_mov_b32 v38, 32
    v_cndmask_b32 v38, v38, 2, vcc
    v_add_u32 v38, v38, v37
    v_lshl_add_u32 v37, v37, 2, s36
    v_lshl_add_u32 v38, v38, 2, s36
    v_lshl_add_u32 v39, v2, 6, v3
    v_add_u32 v39, 512, v39
    v_lshl_add_u32 v39, v39, 2, s36
    s_waitcnt lgkmcnt(0)
    s_lshl_b32 s36, s33, 4
    s_lshr_b32 s39, s39, s36
    s_lshl_b32 s39, s39, 16
    s_lshr_b32 s40, s40, s36
    s_lshl_b32 s40, s40, 16
    v_mov_b32 v40, 0x3fb8aa3b
    v_mul_f32 v40, s39, v40
    v_exp_f32 v40, v40
    s_nop 0
    v_cvt_pk_bf16_f32 v40, v40, v40
    v_and_b32 v40, 0xffff0000, v40
    s_cmp_eq_u32 s34, 0
    s_cselect_b32 s40, s40, 0
    v_mov_b32 v41, s40
    v_cmp_eq_u32 vcc, 0, v1
    s_nop 1
    v_cndmask_b32 v41, 0, v41, vcc
    v_lshrrev_b32 v2, 2, v1
    v_lshlrev_b32 v42, 4, v2
    v_and_b32 v2, 3, v1
    v_lshl_add_u32 v42, v2, 1, v42
    s_mul_i32 s41, s33, 17408
    v_mov_b32 v44, 0
    v_mov_b32 v45, 0
    v_mov_b32 v46, 0
    v_mov_b32 v47, 0
    v_mov_b32 v48, 0
    v_mov_b32 v49, 0
    v_mov_b32 v50, 0
    v_mov_b32 v51, 0
    v_mov_b32 v52, 0
    v_mov_b32 v53, 0
    v_mov_b32 v54, 0
    v_mov_b32 v55, 0
    s_waitcnt vmcnt(0)
    v_lshlrev_b32 v184, 16, v6
    v_mul_f32 v184, 0x3fb8aa3b, v184
    v_exp_f32 v184, v184
    v_lshlrev_b32 v185, 16, v7
    v_lshlrev_b32 v186, 16, v8
    v_lshlrev_b32 v187, 16, v9
    v_cvt_pk_bf16_f32 v184, v184, v184
    v_and_b32 v184, 0xffff0000, v184
    v_mul_f32 v188, v184, v40
    v_mul_f32 v189, v185, v40
    v_mul_f32 v188, 0xbfb8aa3b, v188
    v_mul_f32 v189, 0x3e22f983, v189
    v_mul_f32 v186, v186, v40
    v_mul_f32 v187, v187, v40
    v_add_f32 v118, v186, v186
    v_add_f32 v119, v187, v187
    v_mul_f32 v184, 0x41000000, v188
    v_mul_f32 v185, 0x41000000, v189
    v_exp_f32 v184, v184
    v_fract_f32 v185, v185
    v_cos_f32 v110, v185
    v_sin_f32 v111, v185
    v_mul_f32 v110, v184, v110
    v_mul_f32 v111, -v184, v111
    v_mul_f32 v184, 0x43000000, v188
    v_mul_f32 v185, 0x43000000, v189
    v_exp_f32 v184, v184
    v_fract_f32 v185, v185
    v_cos_f32 v114, v185
    v_sin_f32 v115, v185
    v_mul_f32 v114, v184, v114
    v_mul_f32 v115, v184, v115
    v_exp_f32 v184, v188
    v_fract_f32 v185, v189
    v_cos_f32 v104, v185
    v_sin_f32 v105, v185
    v_mul_f32 v104, v184, v104
    v_mul_f32 v105, v184, v105
    v_pk_mul_f32 v[112:113], v[110:111], v[110:111] op_sel:[0,0] op_sel_hi:[1,0]
    v_pk_mul_f32 v[116:117], v[114:115], v[114:115] op_sel:[0,0] op_sel_hi:[1,0]
    v_pk_mul_f32 v[106:107], v[104:105], v[104:105] op_sel:[0,0] op_sel_hi:[1,0]
    v_pk_mul_f32 v[120:121], v[118:119], v[114:115] op_sel:[0,0] op_sel_hi:[1,0]
    v_pk_fma_f32 v[112:113], v[110:111], v[110:111], v[112:113] op_sel:[1,1,0] op_sel_hi:[0,1,1] neg_lo:[0,1,0]
    v_pk_fma_f32 v[116:117], v[114:115], v[114:115], v[116:117] op_sel:[1,1,0] op_sel_hi:[0,1,1] neg_lo:[0,1,0]
    v_pk_fma_f32 v[106:107], v[104:105], v[104:105], v[106:107] op_sel:[1,1,0] op_sel_hi:[0,1,1] neg_lo:[0,1,0]
    v_pk_fma_f32 v[120:121], v[118:119], v[114:115], v[120:121] op_sel:[1,1,0] op_sel_hi:[0,1,1] neg_lo:[0,1,0]
    v_mov_b32 v168, 0x3f80
    v_cvt_pk_bf16_f32 v169, v110, v111
    v_cvt_pk_bf16_f32 v170, v112, v113
    v_pk_mul_f32 v[152:153], v[110:111], v[112:113] op_sel:[0,0] op_sel_hi:[1,0]
    v_pk_mul_f32 v[154:155], v[112:113], v[112:113] op_sel:[0,0] op_sel_hi:[1,0]
    v_pk_mul_f32 v[108:109], v[106:107], v[106:107] op_sel:[0,0] op_sel_hi:[1,0]
    v_pk_mul_f32 v[122:123], v[118:119], v[116:117] op_sel:[0,0] op_sel_hi:[1,0]
    v_pk_mul_f32 v[124:125], v[120:121], v[116:117] op_sel:[0,0] op_sel_hi:[1,0]
    v_pk_fma_f32 v[152:153], v[110:111], v[112:113], v[152:153] op_sel:[1,1,0] op_sel_hi:[0,1,1] neg_lo:[0,1,0]
    v_pk_fma_f32 v[154:155], v[112:113], v[112:113], v[154:155] op_sel:[1,1,0] op_sel_hi:[0,1,1] neg_lo:[0,1,0]
    v_pk_fma_f32 v[108:109], v[106:107], v[106:107], v[108:109] op_sel:[1,1,0] op_sel_hi:[0,1,1] neg_lo:[0,1,0]
    v_pk_fma_f32 v[122:123], v[118:119], v[116:117], v[122:123] op_sel:[1,1,0] op_sel_hi:[0,1,1] neg_lo:[0,1,0]
    v_pk_fma_f32 v[124:125], v[120:121], v[116:117], v[124:125] op_sel:[1,1,0] op_sel_hi:[0,1,1] neg_lo:[0,1,0]
    v_cvt_pk_bf16_f32 v171, v152, v153
    v_cvt_pk_bf16_f32 v172, v154, v155
    v_pk_mul_f32 v[156:157], v[152:153], v[112:113] op_sel:[0,0] op_sel_hi:[1,0]
    v_pk_mul_f32 v[158:159], v[154:155], v[112:113] op_sel:[0,0] op_sel_hi:[1,0]
    v_pk_mul_f32 v[126:127], v[122:123], v[116:117] op_sel:[0,0] op_sel_hi:[1,0]
    v_pk_mul_f32 v[128:129], v[124:125], v[116:117] op_sel:[0,0] op_sel_hi:[1,0]
    v_pk_fma_f32 v[156:157], v[152:153], v[112:113], v[156:157] op_sel:[1,1,0] op_sel_hi:[0,1,1] neg_lo:[0,1,0]
    v_pk_fma_f32 v[158:159], v[154:155], v[112:113], v[158:159] op_sel:[1,1,0] op_sel_hi:[0,1,1] neg_lo:[0,1,0]
    v_pk_fma_f32 v[126:127], v[122:123], v[116:117], v[126:127] op_sel:[1,1,0] op_sel_hi:[0,1,1] neg_lo:[0,1,0]
    v_pk_fma_f32 v[128:129], v[124:125], v[116:117], v[128:129] op_sel:[1,1,0] op_sel_hi:[0,1,1] neg_lo:[0,1,0]
    v_cvt_pk_bf16_f32 v173, v156, v157
    v_cvt_pk_bf16_f32 v174, v158, v159
    v_pk_mul_f32 v[152:153], v[156:157], v[112:113] op_sel:[0,0] op_sel_hi:[1,0]
    v_pk_mul_f32 v[154:155], v[158:159], v[112:113] op_sel:[0,0] op_sel_hi:[1,0]
    v_pk_mul_f32 v[130:131], v[126:127], v[116:117] op_sel:[0,0] op_sel_hi:[1,0]
    v_pk_mul_f32 v[132:133], v[128:129], v[116:117] op_sel:[0,0] op_sel_hi:[1,0]
    v_pk_fma_f32 v[152:153], v[156:157], v[112:113], v[152:153] op_sel:[1,1,0] op_sel_hi:[0,1,1] neg_lo:[0,1,0]
    v_pk_fma_f32 v[154:155], v[158:159], v[112:113], v[154:155] op_sel:[1,1,0] op_sel_hi:[0,1,1] neg_lo:[0,1,0]
    v_pk_fma_f32 v[130:131], v[126:127], v[116:117], v[130:131] op_sel:[1,1,0] op_sel_hi:[0,1,1] neg_lo:[0,1,0]
    v_pk_fma_f32 v[132:133], v[128:129], v[116:117], v[132:133] op_sel:[1,1,0] op_sel_hi:[0,1,1] neg_lo:[0,1,0]
    v_cvt_pk_bf16_f32 v175, v152, v153
    v_cvt_pk_bf16_f32 v176, v154, v155
    v_pk_mul_f32 v[156:157], v[152:153], v[112:113] op_sel:[0,0] op_sel_hi:[1,0]
    v_pk_mul_f32 v[158:159], v[154:155], v[112:113] op_sel:[0,0] op_sel_hi:[1,0]
    v_pk_mul_f32 v[134:135], v[130:131], v[116:117] op_sel:[0,0] op_sel_hi:[1,0]
    v_pk_mul_f32 v[136:137], v[132:133], v[116:117] op_sel:[0,0] op_sel_hi:[1,0]
    v_pk_fma_f32 v[156:157], v[152:153], v[112:113], v[156:157] op_sel:[1,1,0] op_sel_hi:[0,1,1] neg_lo:[0,1,0]
    v_pk_fma_f32 v[158:159], v[154:155], v[112:113], v[158:159] op_sel:[1,1,0] op_sel_hi:[0,1,1] neg_lo:[0,1,0]
    v_pk_fma_f32 v[134:135], v[130:131], v[116:117], v[134:135] op_sel:[1,1,0] op_sel_hi:[0,1,1] neg_lo:[0,1,0]
    v_pk_fma_f32 v[136:137], v[132:133], v[116:117], v[136:137] op_sel:[1,1,0] op_sel_hi:[0,1,1] neg_lo:[0,1,0]
    v_cvt_pk_bf16_f32 v177, v156, v157
    v_cvt_pk_bf16_f32 v178, v158, v159
    v_pk_mul_f32 v[152:153], v[156:157], v[112:113] op_sel:[0,0] op_sel_hi:[1,0]
    v_pk_mul_f32 v[154:155], v[158:159], v[112:113] op_sel:[0,0] op_sel_hi:[1,0]
    v_pk_mul_f32 v[138:139], v[134:135], v[116:117] op_sel:[0,0] op_sel_hi:[1,0]
    v_pk_mul_f32 v[140:141], v[136:137], v[116:117] op_sel:[0,0] op_sel_hi:[1,0]
    v_pk_fma_f32 v[152:153], v[156:157], v[112:113], v[152:153] op_sel:[1,1,0] op_sel_hi:[0,1,1] neg_lo:[0,1,0]
    v_pk_fma_f32 v[154:155], v[158:159], v[112:113], v[154:155] op_sel:[1,1,0] op_sel_hi:[0,1,1] neg_lo:[0,1,0]
    v_pk_fma_f32 v[138:139], v[134:135], v[116:117], v[138:139] op_sel:[1,1,0] op_sel_hi:[0,1,1] neg_lo:[0,1,0]
    v_pk_fma_f32 v[140:141], v[136:137], v[116:117], v[140:141] op_sel:[1,1,0] op_sel_hi:[0,1,1] neg_lo:[0,1,0]
    v_cvt_pk_bf16_f32 v179, v152, v153
    v_cvt_pk_bf16_f32 v180, v154, v155
    v_pk_mul_f32 v[156:157], v[152:153], v[112:113] op_sel:[0,0] op_sel_hi:[1,0]
    v_pk_mul_f32 v[158:159], v[154:155], v[112:113] op_sel:[0,0] op_sel_hi:[1,0]
    v_pk_mul_f32 v[142:143], v[138:139], v[116:117] op_sel:[0,0] op_sel_hi:[1,0]
    v_pk_mul_f32 v[144:145], v[140:141], v[116:117] op_sel:[0,0] op_sel_hi:[1,0]
    v_pk_fma_f32 v[156:157], v[152:153], v[112:113], v[156:157] op_sel:[1,1,0] op_sel_hi:[0,1,1] neg_lo:[0,1,0]
    v_pk_fma_f32 v[158:159], v[154:155], v[112:113], v[158:159] op_sel:[1,1,0] op_sel_hi:[0,1,1] neg_lo:[0,1,0]
    v_pk_fma_f32 v[142:143], v[138:139], v[116:117], v[142:143] op_sel:[1,1,0] op_sel_hi:[0,1,1] neg_lo:[0,1,0]
    v_pk_fma_f32 v[144:145], v[140:141], v[116:117], v[144:145] op_sel:[1,1,0] op_sel_hi:[0,1,1] neg_lo:[0,1,0]
    v_cvt_pk_bf16_f32 v181, v156, v157
    v_cvt_pk_bf16_f32 v182, v158, v159
    v_pk_mul_f32 v[152:153], v[156:157], v[112:113] op_sel:[0,0] op_sel_hi:[1,0]
    v_pk_mul_f32 v[146:147], v[142:143], v[116:117] op_sel:[0,0] op_sel_hi:[1,0]
    v_pk_mul_f32 v[148:149], v[144:145], v[116:117] op_sel:[0,0] op_sel_hi:[1,0]
    v_pk_fma_f32 v[152:153], v[156:157], v[112:113], v[152:153] op_sel:[1,1,0] op_sel_hi:[0,1,1] neg_lo:[0,1,0]
    v_pk_fma_f32 v[146:147], v[142:143], v[116:117], v[146:147] op_sel:[1,1,0] op_sel_hi:[0,1,1] neg_lo:[0,1,0]
    v_pk_fma_f32 v[148:149], v[144:145], v[116:117], v[148:149] op_sel:[1,1,0] op_sel_hi:[0,1,1] neg_lo:[0,1,0]
    v_cvt_pk_bf16_f32 v183, v152, v153
    v_pk_mul_f32 v[150:151], v[146:147], v[116:117] op_sel:[0,0] op_sel_hi:[1,0]
    v_pk_fma_f32 v[150:151], v[146:147], v[116:117], v[150:151] op_sel:[1,1,0] op_sel_hi:[0,1,1] neg_lo:[0,1,0]
    ds_write2_b32 v34, v168, v169 offset0:0 offset1:4
    ds_write2_b32 v34, v170, v171 offset0:8 offset1:12
    ds_write2_b32 v34, v172, v173 offset0:16 offset1:20
    ds_write2_b32 v34, v174, v175 offset0:24 offset1:28
    ds_write2_b32 v34, v176, v177 offset0:32 offset1:36
    ds_write2_b32 v34, v178, v179 offset0:40 offset1:44
    ds_write2_b32 v34, v180, v181 offset0:48 offset1:52
    ds_write2_b32 v34, v182, v183 offset0:56 offset1:60
    ds_read_b128 v[56:59], v35 offset:0
    ds_read_b128 v[60:63], v35 offset:1088
    ds_read_b128 v[64:67], v35 offset:2176
    ds_read_b128 v[68:71], v35 offset:3264
    v_cvt_pk_bf16_f32 v168, v118, v119
    v_cvt_pk_bf16_f32 v176, v120, v121
    v_pk_mul_f32 v[156:157], v[118:119], v[104:105] op_sel:[0,0] op_sel_hi:[1,0]
    v_pk_mul_f32 v[158:159], v[120:121], v[104:105] op_sel:[0,0] op_sel_hi:[1,0]
    v_pk_fma_f32 v[156:157], v[118:119], v[104:105], v[156:157] op_sel:[1,1,0] op_sel_hi:[0,1,1] neg_lo:[0,1,0]
    v_pk_fma_f32 v[158:159], v[120:121], v[104:105], v[158:159] op_sel:[1,1,0] op_sel_hi:[0,1,1] neg_lo:[0,1,0]
    v_cvt_pk_bf16_f32 v169, v156, v157
    v_cvt_pk_bf16_f32 v177, v158, v159
    v_pk_mul_f32 v[152:153], v[156:157], v[104:105] op_sel:[0,0] op_sel_hi:[1,0]
    v_pk_mul_f32 v[154:155], v[158:159], v[104:105] op_sel:[0,0] op_sel_hi:[1,0]
    v_pk_fma_f32 v[152:153], v[156:157], v[104:105], v[152:153] op_sel:[1,1,0] op_sel_hi:[0,1,1] neg_lo:[0,1,0]
    v_pk_fma_f32 v[154:155], v[158:159], v[104:105], v[154:155] op_sel:[1,1,0] op_sel_hi:[0,1,1] neg_lo:[0,1,0]
    v_cvt_pk_bf16_f32 v170, v152, v153
    v_cvt_pk_bf16_f32 v178, v154, v155
    v_pk_mul_f32 v[156:157], v[152:153], v[104:105] op_sel:[0,0] op_sel_hi:[1,0]
    v_pk_mul_f32 v[158:159], v[154:155], v[104:105] op_sel:[0,0] op_sel_hi:[1,0]
    v_pk_fma_f32 v[156:157], v[152:153], v[104:105], v[156:157] op_sel:[1,1,0] op_sel_hi:[0,1,1] neg_lo:[0,1,0]
    v_pk_fma_f32 v[158:159], v[154:155], v[104:105], v[158:159] op_sel:[1,1,0] op_sel_hi:[0,1,1] neg_lo:[0,1,0]
    v_cvt_pk_bf16_f32 v171, v156, v157
    v_cvt_pk_bf16_f32 v179, v158, v159
    v_pk_mul_f32 v[152:153], v[156:157], v[104:105] op_sel:[0,0] op_sel_hi:[1,0]
    v_pk_mul_f32 v[154:155], v[158:159], v[104:105] op_sel:[0,0] op_sel_hi:[1,0]
    v_pk_fma_f32 v[152:153], v[156:157], v[104:105], v[152:153] op_sel:[1,1,0] op_sel_hi:[0,1,1] neg_lo:[0,1,0]
    v_pk_fma_f32 v[154:155], v[158:159], v[104:105], v[154:155] op_sel:[1,1,0] op_sel_hi:[0,1,1] neg_lo:[0,1,0]
    v_cvt_pk_bf16_f32 v172, v152, v153
    v_cvt_pk_bf16_f32 v180, v154, v155
    v_pk_mul_f32 v[156:157], v[152:153], v[104:105] op_sel:[0,0] op_sel_hi:[1,0]
    v_pk_mul_f32 v[158:159], v[154:155], v[104:105] op_sel:[0,0] op_sel_hi:[1,0]
    v_pk_fma_f32 v[156:157], v[152:153], v[104:105], v[156:157] op_sel:[1,1,0] op_sel_hi:[0,1,1] neg_lo:[0,1,0]
    v_pk_fma_f32 v[158:159], v[154:155], v[104:105], v[158:159] op_sel:[1,1,0] op_sel_hi:[0,1,1] neg_lo:[0,1,0]
    v_cvt_pk_bf16_f32 v173, v156, v157
    v_cvt_pk_bf16_f32 v181, v158, v159
    v_pk_mul_f32 v[152:153], v[156:157], v[104:105] op_sel:[0,0] op_sel_hi:[1,0]
    v_pk_mul_f32 v[154:155], v[158:159], v[104:105] op_sel:[0,0] op_sel_hi:[1,0]
    v_pk_fma_f32 v[152:153], v[156:157], v[104:105], v[152:153] op_sel:[1,1,0] op_sel_hi:[0,1,1] neg_lo:[0,1,0]
    v_pk_fma_f32 v[154:155], v[158:159], v[104:105], v[154:155] op_sel:[1,1,0] op_sel_hi:[0,1,1] neg_lo:[0,1,0]
    v_cvt_pk_bf16_f32 v174, v152, v153
    v_cvt_pk_bf16_f32 v182, v154, v155
    v_pk_mul_f32 v[156:157], v[152:153], v[104:105] op_sel:[0,0] op_sel_hi:[1,0]
    v_pk_mul_f32 v[158:159], v[154:155], v[104:105] op_sel:[0,0] op_sel_hi:[1,0]
    v_pk_fma_f32 v[156:157], v[152:153], v[104:105], v[156:157] op_sel:[1,1,0] op_sel_hi:[0,1,1] neg_lo:[0,1,0]
    v_pk_fma_f32 v[158:159], v[154:155], v[104:105], v[158:159] op_sel:[1,1,0] op_sel_hi:[0,1,1] neg_lo:[0,1,0]
    v_cvt_pk_bf16_f32 v175, v156, v157
    v_cvt_pk_bf16_f32 v183, v158, v159
    ds_write2_b32 v34, v168, v169 offset0:0 offset1:4
    ds_write2_b32 v34, v170, v171 offset0:8 offset1:12
    ds_write2_b32 v34, v172, v173 offset0:16 offset1:20
    ds_write2_b32 v34, v174, v175 offset0:24 offset1:28
    ds_write2_b32 v34, v176, v177 offset0:32 offset1:36
    ds_write2_b32 v34, v178, v179 offset0:40 offset1:44
    ds_write2_b32 v34, v180, v181 offset0:48 offset1:52
    ds_write2_b32 v34, v182, v183 offset0:56 offset1:60
    ds_read_b128 v[72:75], v35 offset:0
    ds_read_b128 v[76:79], v35 offset:1088
    ds_read_b128 v[80:83], v35 offset:2176
    ds_read_b128 v[84:87], v35 offset:3264
    v_cvt_pk_bf16_f32 v168, v122, v123
    v_cvt_pk_bf16_f32 v172, v124, v125
    v_pk_mul_f32 v[156:157], v[122:123], v[106:107] op_sel:[0,0] op_sel_hi:[1,0]
    v_pk_mul_f32 v[158:159], v[124:125], v[106:107] op_sel:[0,0] op_sel_hi:[1,0]
    v_pk_fma_f32 v[156:157], v[122:123], v[106:107], v[156:157] op_sel:[1,1,0] op_sel_hi:[0,1,1] neg_lo:[0,1,0]
    v_pk_fma_f32 v[158:159], v[124:125], v[106:107], v[158:159] op_sel:[1,1,0] op_sel_hi:[0,1,1] neg_lo:[0,1,0]
    v_cvt_pk_bf16_f32 v169, v156, v157
    v_cvt_pk_bf16_f32 v173, v158, v159
    v_pk_mul_f32 v[152:153], v[156:157], v[106:107] op_sel:[0,0] op_sel_hi:[1,0]
    v_pk_mul_f32 v[154:155], v[158:159], v[106:107] op_sel:[0,0] op_sel_hi:[1,0]
    v_pk_fma_f32 v[152:153], v[156:157], v[106:107], v[152:153] op_sel:[1,1,0] op_sel_hi:[0,1,1] neg_lo:[0,1,0]
    v_pk_fma_f32 v[154:155], v[158:159], v[106:107], v[154:155] op_sel:[1,1,0] op_sel_hi:[0,1,1] neg_lo:[0,1,0]
    v_cvt_pk_bf16_f32 v170, v152, v153
    v_cvt_pk_bf16_f32 v174, v154, v155
    v_pk_mul_f32 v[156:157], v[152:153], v[106:107] op_sel:[0,0] op_sel_hi:[1,0]
    v_pk_mul_f32 v[158:159], v[154:155], v[106:107] op_sel:[0,0] op_sel_hi:[1,0]
    v_pk_fma_f32 v[156:157], v[152:153], v[106:107], v[156:157] op_sel:[1,1,0] op_sel_hi:[0,1,1] neg_lo:[0,1,0]
    v_pk_fma_f32 v[158:159], v[154:155], v[106:107], v[158:159] op_sel:[1,1,0] op_sel_hi:[0,1,1] neg_lo:[0,1,0]
    v_cvt_pk_bf16_f32 v171, v156, v157
    v_cvt_pk_bf16_f32 v175, v158, v159
    v_pk_mul_f32 v[160:161], v[126:127], v[108:109] op_sel:[0,0] op_sel_hi:[1,0]
    v_pk_mul_f32 v[162:163], v[128:129], v[108:109] op_sel:[0,0] op_sel_hi:[1,0]
    v_pk_mul_f32 v[164:165], v[130:131], v[108:109] op_sel:[0,0] op_sel_hi:[1,0]
    v_pk_mul_f32 v[166:167], v[132:133], v[108:109] op_sel:[0,0] op_sel_hi:[1,0]
    v_pk_fma_f32 v[160:161], v[126:127], v[108:109], v[160:161] op_sel:[1,1,0] op_sel_hi:[0,1,1] neg_lo:[0,1,0]
    v_pk_fma_f32 v[162:163], v[128:129], v[108:109], v[162:163] op_sel:[1,1,0] op_sel_hi:[0,1,1] neg_lo:[0,1,0]
    v_pk_fma_f32 v[164:165], v[130:131], v[108:109], v[164:165] op_sel:[1,1,0] op_sel_hi:[0,1,1] neg_lo:[0,1,0]
    v_pk_fma_f32 v[166:167], v[132:133], v[108:109], v[166:167] op_sel:[1,1,0] op_sel_hi:[0,1,1] neg_lo:[0,1,0]
    v_cvt_pk_bf16_f32 v176, v126, v127
    v_cvt_pk_bf16_f32 v177, v160, v161
    v_cvt_pk_bf16_f32 v178, v128, v129
    v_cvt_pk_bf16_f32 v179, v162, v163
    v_cvt_pk_bf16_f32 v180, v130, v131
    v_cvt_pk_bf16_f32 v181, v164, v165
    v_cvt_pk_bf16_f32 v182, v132, v133
    v_cvt_pk_bf16_f32 v183, v166, v167
    ds_write2_b32 v34, v168, v169 offset0:0 offset1:4
    ds_write2_b32 v34, v170, v171 offset0:8 offset1:12
    ds_write2_b32 v34, v172, v173 offset0:16 offset1:20
    ds_write2_b32 v34, v174, v175 offset0:24 offset1:28
    ds_write2_b32 v34, v176, v177 offset0:32 offset1:36
    ds_write2_b32 v34, v178, v179 offset0:40 offset1:44
    ds_write2_b32 v34, v180, v181 offset0:48 offset1:52
    ds_write2_b32 v34, v182, v183 offset0:56 offset1:60
    s_waitcnt lgkmcnt(8)
    v_mfma_f32_16x16x32_bf16 v[44:47], v[72:75], v[56:59], v[44:47]
    v_mfma_f32_16x16x32_bf16 v[44:47], v[76:79], v[60:63], v[44:47]
    v_mfma_f32_16x16x32_bf16 v[44:47], v[80:83], v[64:67], v[44:47]
    v_mfma_f32_16x16x32_bf16 v[44:47], v[84:87], v[68:71], v[44:47]
    ds_read_b128 v[88:91], v35 offset:0
    ds_read_b128 v[92:95], v35 offset:1088
    ds_read_b128 v[96:99], v35 offset:2176
    ds_read_b128 v[100:103], v35 offset:3264
    v_cvt_pk_bf16_f32 v168, v134, v135
    v_cvt_pk_bf16_f32 v169, v136, v137
    v_cvt_pk_bf16_f32 v170, v138, v139
    v_cvt_pk_bf16_f32 v171, v140, v141
    v_cvt_pk_bf16_f32 v172, v142, v143
    v_cvt_pk_bf16_f32 v173, v144, v145
    v_cvt_pk_bf16_f32 v174, v146, v147
    v_cvt_pk_bf16_f32 v175, v148, v149
    v_cvt_pk_bf16_f32 v176, v150, v151
    ds_write2_b32 v34, v168, v169 offset0:0 offset1:4
    ds_write2_b32 v34, v170, v171 offset0:8 offset1:12
    ds_write2_b32 v34, v172, v173 offset0:16 offset1:20
    ds_write2_b32 v34, v174, v175 offset0:24 offset1:28
    ds_write_b32 v34, v176 offset:128
    s_waitcnt lgkmcnt(5)
    v_mfma_f32_16x16x32_bf16 v[48:51], v[88:91], v[56:59], v[48:51]
    v_mfma_f32_16x16x32_bf16 v[48:51], v[92:95], v[60:63], v[48:51]
    v_mfma_f32_16x16x32_bf16 v[48:51], v[96:99], v[64:67], v[48:51]
    v_mfma_f32_16x16x32_bf16 v[48:51], v[100:103], v[68:71], v[48:51]
    ds_read_b128 v[72:75], v35 offset:0
    ds_read_b128 v[76:79], v35 offset:1088
    ds_read_b128 v[80:83], v35 offset:2176
    ds_read_b128 v[84:87], v35 offset:3264
    v_and_b32 v248, 63, v0
    v_lshlrev_b32 v248, 2, v248
    buffer_load_dword v249, v248, s[44:47], 0 offen sc1
    s_setprio 0
    v_and_b32 v184, 0xffff0000, v6
    v_mul_f32 v184, 0x3fb8aa3b, v184
    v_exp_f32 v184, v184
    v_and_b32 v185, 0xffff0000, v7
    v_and_b32 v186, 0xffff0000, v8
    v_and_b32 v187, 0xffff0000, v9
    v_cvt_pk_bf16_f32 v184, v184, v184
    v_and_b32 v184, 0xffff0000, v184
    v_mul_f32 v188, v184, v40
    v_mul_f32 v189, v185, v40
    v_mul_f32 v188, 0xbfb8aa3b, v188
    v_mul_f32 v189, 0x3e22f983, v189
    v_mul_f32 v186, v186, v40
    v_mul_f32 v187, v187, v40
    v_add_f32 v118, v186, v186
    v_add_f32 v119, v187, v187
    v_mul_f32 v184, 0x41000000, v188
    v_mul_f32 v185, 0x41000000, v189
    v_exp_f32 v184, v184
    v_fract_f32 v185, v185
    v_cos_f32 v110, v185
    v_sin_f32 v111, v185
    v_mul_f32 v110, v184, v110
    v_mul_f32 v111, -v184, v111
    v_mul_f32 v184, 0x43000000, v188
    v_mul_f32 v185, 0x43000000, v189
    v_exp_f32 v184, v184
    v_fract_f32 v185, v185
    v_cos_f32 v114, v185
    v_sin_f32 v115, v185
    v_mul_f32 v114, v184, v114
    v_mul_f32 v115, v184, v115
    v_exp_f32 v184, v188
    v_fract_f32 v185, v189
    v_cos_f32 v104, v185
    v_sin_f32 v105, v185
    v_mul_f32 v104, v184, v104
    v_mul_f32 v105, v184, v105
    s_waitcnt lgkmcnt(0)
    v_mfma_f32_16x16x32_bf16 v[52:55], v[72:75], v[56:59], v[52:55]
    v_mfma_f32_16x16x32_bf16 v[52:55], v[76:79], v[60:63], v[52:55]
    v_mfma_f32_16x16x32_bf16 v[52:55], v[80:83], v[64:67], v[52:55]
    v_mfma_f32_16x16x32_bf16 v[52:55], v[84:87], v[68:71], v[52:55]
    v_pk_mul_f32 v[112:113], v[110:111], v[110:111] op_sel:[0,0] op_sel_hi:[1,0]
    v_pk_mul_f32 v[116:117], v[114:115], v[114:115] op_sel:[0,0] op_sel_hi:[1,0]
    v_pk_mul_f32 v[106:107], v[104:105], v[104:105] op_sel:[0,0] op_sel_hi:[1,0]
    v_pk_mul_f32 v[120:121], v[118:119], v[114:115] op_sel:[0,0] op_sel_hi:[1,0]
    v_pk_fma_f32 v[112:113], v[110:111], v[110:111], v[112:113] op_sel:[1,1,0] op_sel_hi:[0,1,1] neg_lo:[0,1,0]
    v_pk_fma_f32 v[116:117], v[114:115], v[114:115], v[116:117] op_sel:[1,1,0] op_sel_hi:[0,1,1] neg_lo:[0,1,0]
    v_pk_fma_f32 v[106:107], v[104:105], v[104:105], v[106:107] op_sel:[1,1,0] op_sel_hi:[0,1,1] neg_lo:[0,1,0]
    v_pk_fma_f32 v[120:121], v[118:119], v[114:115], v[120:121] op_sel:[1,1,0] op_sel_hi:[0,1,1] neg_lo:[0,1,0]
    v_mov_b32 v168, 0x3f80
    v_cvt_pk_bf16_f32 v169, v110, v111
    v_cvt_pk_bf16_f32 v170, v112, v113
    v_pk_mul_f32 v[152:153], v[110:111], v[112:113] op_sel:[0,0] op_sel_hi:[1,0]
    v_pk_mul_f32 v[154:155], v[112:113], v[112:113] op_sel:[0,0] op_sel_hi:[1,0]
    v_pk_mul_f32 v[108:109], v[106:107], v[106:107] op_sel:[0,0] op_sel_hi:[1,0]
    v_pk_mul_f32 v[122:123], v[118:119], v[116:117] op_sel:[0,0] op_sel_hi:[1,0]
    v_pk_mul_f32 v[124:125], v[120:121], v[116:117] op_sel:[0,0] op_sel_hi:[1,0]
    v_pk_fma_f32 v[152:153], v[110:111], v[112:113], v[152:153] op_sel:[1,1,0] op_sel_hi:[0,1,1] neg_lo:[0,1,0]
    v_pk_fma_f32 v[154:155], v[112:113], v[112:113], v[154:155] op_sel:[1,1,0] op_sel_hi:[0,1,1] neg_lo:[0,1,0]
    v_pk_fma_f32 v[108:109], v[106:107], v[106:107], v[108:109] op_sel:[1,1,0] op_sel_hi:[0,1,1] neg_lo:[0,1,0]
    v_pk_fma_f32 v[122:123], v[118:119], v[116:117], v[122:123] op_sel:[1,1,0] op_sel_hi:[0,1,1] neg_lo:[0,1,0]
    v_pk_fma_f32 v[124:125], v[120:121], v[116:117], v[124:125] op_sel:[1,1,0] op_sel_hi:[0,1,1] neg_lo:[0,1,0]
    v_cvt_pk_bf16_f32 v171, v152, v153
    v_cvt_pk_bf16_f32 v172, v154, v155
    v_pk_mul_f32 v[156:157], v[152:153], v[112:113] op_sel:[0,0] op_sel_hi:[1,0]
    v_pk_mul_f32 v[158:159], v[154:155], v[112:113] op_sel:[0,0] op_sel_hi:[1,0]
    v_pk_mul_f32 v[126:127], v[122:123], v[116:117] op_sel:[0,0] op_sel_hi:[1,0]
    v_pk_mul_f32 v[128:129], v[124:125], v[116:117] op_sel:[0,0] op_sel_hi:[1,0]
    v_pk_fma_f32 v[156:157], v[152:153], v[112:113], v[156:157] op_sel:[1,1,0] op_sel_hi:[0,1,1] neg_lo:[0,1,0]
    v_pk_fma_f32 v[158:159], v[154:155], v[112:113], v[158:159] op_sel:[1,1,0] op_sel_hi:[0,1,1] neg_lo:[0,1,0]
    v_pk_fma_f32 v[126:127], v[122:123], v[116:117], v[126:127] op_sel:[1,1,0] op_sel_hi:[0,1,1] neg_lo:[0,1,0]
    v_pk_fma_f32 v[128:129], v[124:125], v[116:117], v[128:129] op_sel:[1,1,0] op_sel_hi:[0,1,1] neg_lo:[0,1,0]
    v_cvt_pk_bf16_f32 v173, v156, v157
    v_cvt_pk_bf16_f32 v174, v158, v159
    v_pk_mul_f32 v[152:153], v[156:157], v[112:113] op_sel:[0,0] op_sel_hi:[1,0]
    v_pk_mul_f32 v[154:155], v[158:159], v[112:113] op_sel:[0,0] op_sel_hi:[1,0]
    v_pk_mul_f32 v[130:131], v[126:127], v[116:117] op_sel:[0,0] op_sel_hi:[1,0]
    v_pk_mul_f32 v[132:133], v[128:129], v[116:117] op_sel:[0,0] op_sel_hi:[1,0]
    v_pk_fma_f32 v[152:153], v[156:157], v[112:113], v[152:153] op_sel:[1,1,0] op_sel_hi:[0,1,1] neg_lo:[0,1,0]
    v_pk_fma_f32 v[154:155], v[158:159], v[112:113], v[154:155] op_sel:[1,1,0] op_sel_hi:[0,1,1] neg_lo:[0,1,0]
    v_pk_fma_f32 v[130:131], v[126:127], v[116:117], v[130:131] op_sel:[1,1,0] op_sel_hi:[0,1,1] neg_lo:[0,1,0]
    v_pk_fma_f32 v[132:133], v[128:129], v[116:117], v[132:133] op_sel:[1,1,0] op_sel_hi:[0,1,1] neg_lo:[0,1,0]
    v_cvt_pk_bf16_f32 v175, v152, v153
    v_cvt_pk_bf16_f32 v176, v154, v155
    v_pk_mul_f32 v[156:157], v[152:153], v[112:113] op_sel:[0,0] op_sel_hi:[1,0]
    v_pk_mul_f32 v[158:159], v[154:155], v[112:113] op_sel:[0,0] op_sel_hi:[1,0]
    v_pk_mul_f32 v[134:135], v[130:131], v[116:117] op_sel:[0,0] op_sel_hi:[1,0]
    v_pk_mul_f32 v[136:137], v[132:133], v[116:117] op_sel:[0,0] op_sel_hi:[1,0]
    v_pk_fma_f32 v[156:157], v[152:153], v[112:113], v[156:157] op_sel:[1,1,0] op_sel_hi:[0,1,1] neg_lo:[0,1,0]
    v_pk_fma_f32 v[158:159], v[154:155], v[112:113], v[158:159] op_sel:[1,1,0] op_sel_hi:[0,1,1] neg_lo:[0,1,0]
    v_pk_fma_f32 v[134:135], v[130:131], v[116:117], v[134:135] op_sel:[1,1,0] op_sel_hi:[0,1,1] neg_lo:[0,1,0]
    v_pk_fma_f32 v[136:137], v[132:133], v[116:117], v[136:137] op_sel:[1,1,0] op_sel_hi:[0,1,1] neg_lo:[0,1,0]
    v_cvt_pk_bf16_f32 v177, v156, v157
    v_cvt_pk_bf16_f32 v178, v158, v159
    v_pk_mul_f32 v[152:153], v[156:157], v[112:113] op_sel:[0,0] op_sel_hi:[1,0]
    v_pk_mul_f32 v[154:155], v[158:159], v[112:113] op_sel:[0,0] op_sel_hi:[1,0]
    v_pk_mul_f32 v[138:139], v[134:135], v[116:117] op_sel:[0,0] op_sel_hi:[1,0]
    v_pk_mul_f32 v[140:141], v[136:137], v[116:117] op_sel:[0,0] op_sel_hi:[1,0]
    v_pk_fma_f32 v[152:153], v[156:157], v[112:113], v[152:153] op_sel:[1,1,0] op_sel_hi:[0,1,1] neg_lo:[0,1,0]
    v_pk_fma_f32 v[154:155], v[158:159], v[112:113], v[154:155] op_sel:[1,1,0] op_sel_hi:[0,1,1] neg_lo:[0,1,0]
    v_pk_fma_f32 v[138:139], v[134:135], v[116:117], v[138:139] op_sel:[1,1,0] op_sel_hi:[0,1,1] neg_lo:[0,1,0]
    v_pk_fma_f32 v[140:141], v[136:137], v[116:117], v[140:141] op_sel:[1,1,0] op_sel_hi:[0,1,1] neg_lo:[0,1,0]
    v_cvt_pk_bf16_f32 v179, v152, v153
    v_cvt_pk_bf16_f32 v180, v154, v155
    v_pk_mul_f32 v[156:157], v[152:153], v[112:113] op_sel:[0,0] op_sel_hi:[1,0]
    v_pk_mul_f32 v[158:159], v[154:155], v[112:113] op_sel:[0,0] op_sel_hi:[1,0]
    v_pk_mul_f32 v[142:143], v[138:139], v[116:117] op_sel:[0,0] op_sel_hi:[1,0]
    v_pk_mul_f32 v[144:145], v[140:141], v[116:117] op_sel:[0,0] op_sel_hi:[1,0]
    v_pk_fma_f32 v[156:157], v[152:153], v[112:113], v[156:157] op_sel:[1,1,0] op_sel_hi:[0,1,1] neg_lo:[0,1,0]
    v_pk_fma_f32 v[158:159], v[154:155], v[112:113], v[158:159] op_sel:[1,1,0] op_sel_hi:[0,1,1] neg_lo:[0,1,0]
    v_pk_fma_f32 v[142:143], v[138:139], v[116:117], v[142:143] op_sel:[1,1,0] op_sel_hi:[0,1,1] neg_lo:[0,1,0]
    v_pk_fma_f32 v[144:145], v[140:141], v[116:117], v[144:145] op_sel:[1,1,0] op_sel_hi:[0,1,1] neg_lo:[0,1,0]
    v_cvt_pk_bf16_f32 v181, v156, v157
    v_cvt_pk_bf16_f32 v182, v158, v159
    v_pk_mul_f32 v[152:153], v[156:157], v[112:113] op_sel:[0,0] op_sel_hi:[1,0]
    v_pk_mul_f32 v[146:147], v[142:143], v[116:117] op_sel:[0,0] op_sel_hi:[1,0]
    v_pk_mul_f32 v[148:149], v[144:145], v[116:117] op_sel:[0,0] op_sel_hi:[1,0]
    v_pk_fma_f32 v[152:153], v[156:157], v[112:113], v[152:153] op_sel:[1,1,0] op_sel_hi:[0,1,1] neg_lo:[0,1,0]
    v_pk_fma_f32 v[146:147], v[142:143], v[116:117], v[146:147] op_sel:[1,1,0] op_sel_hi:[0,1,1] neg_lo:[0,1,0]
    v_pk_fma_f32 v[148:149], v[144:145], v[116:117], v[148:149] op_sel:[1,1,0] op_sel_hi:[0,1,1] neg_lo:[0,1,0]
    v_cvt_pk_bf16_f32 v183, v152, v153
    v_pk_mul_f32 v[150:151], v[146:147], v[116:117] op_sel:[0,0] op_sel_hi:[1,0]
    v_pk_fma_f32 v[150:151], v[146:147], v[116:117], v[150:151] op_sel:[1,1,0] op_sel_hi:[0,1,1] neg_lo:[0,1,0]
    ds_write2_b32 v34, v168, v169 offset0:0 offset1:4
    ds_write2_b32 v34, v170, v171 offset0:8 offset1:12
    ds_write2_b32 v34, v172, v173 offset0:16 offset1:20
    ds_write2_b32 v34, v174, v175 offset0:24 offset1:28
    ds_write2_b32 v34, v176, v177 offset0:32 offset1:36
    ds_write2_b32 v34, v178, v179 offset0:40 offset1:44
    ds_write2_b32 v34, v180, v181 offset0:48 offset1:52
    ds_write2_b32 v34, v182, v183 offset0:56 offset1:60
    ds_read_b128 v[56:59], v35 offset:0
    ds_read_b128 v[60:63], v35 offset:1088
    ds_read_b128 v[64:67], v35 offset:2176
    ds_read_b128 v[68:71], v35 offset:3264
    v_cvt_pk_bf16_f32 v168, v118, v119
    v_cvt_pk_bf16_f32 v176, v120, v121
    v_pk_mul_f32 v[156:157], v[118:119], v[104:105] op_sel:[0,0] op_sel_hi:[1,0]
    v_pk_mul_f32 v[158:159], v[120:121], v[104:105] op_sel:[0,0] op_sel_hi:[1,0]
    v_pk_fma_f32 v[156:157], v[118:119], v[104:105], v[156:157] op_sel:[1,1,0] op_sel_hi:[0,1,1] neg_lo:[0,1,0]
    v_pk_fma_f32 v[158:159], v[120:121], v[104:105], v[158:159] op_sel:[1,1,0] op_sel_hi:[0,1,1] neg_lo:[0,1,0]
    v_cvt_pk_bf16_f32 v169, v156, v157
    v_cvt_pk_bf16_f32 v177, v158, v159
    v_pk_mul_f32 v[152:153], v[156:157], v[104:105] op_sel:[0,0] op_sel_hi:[1,0]
    v_pk_mul_f32 v[154:155], v[158:159], v[104:105] op_sel:[0,0] op_sel_hi:[1,0]
    v_pk_fma_f32 v[152:153], v[156:157], v[104:105], v[152:153] op_sel:[1,1,0] op_sel_hi:[0,1,1] neg_lo:[0,1,0]
    v_pk_fma_f32 v[154:155], v[158:159], v[104:105], v[154:155] op_sel:[1,1,0] op_sel_hi:[0,1,1] neg_lo:[0,1,0]
    v_cvt_pk_bf16_f32 v170, v152, v153
    v_cvt_pk_bf16_f32 v178, v154, v155
    v_pk_mul_f32 v[156:157], v[152:153], v[104:105] op_sel:[0,0] op_sel_hi:[1,0]
    v_pk_mul_f32 v[158:159], v[154:155], v[104:105] op_sel:[0,0] op_sel_hi:[1,0]
    v_pk_fma_f32 v[156:157], v[152:153], v[104:105], v[156:157] op_sel:[1,1,0] op_sel_hi:[0,1,1] neg_lo:[0,1,0]
    v_pk_fma_f32 v[158:159], v[154:155], v[104:105], v[158:159] op_sel:[1,1,0] op_sel_hi:[0,1,1] neg_lo:[0,1,0]
    v_cvt_pk_bf16_f32 v171, v156, v157
    v_cvt_pk_bf16_f32 v179, v158, v159
    v_pk_mul_f32 v[152:153], v[156:157], v[104:105] op_sel:[0,0] op_sel_hi:[1,0]
    v_pk_mul_f32 v[154:155], v[158:159], v[104:105] op_sel:[0,0] op_sel_hi:[1,0]
    v_pk_fma_f32 v[152:153], v[156:157], v[104:105], v[152:153] op_sel:[1,1,0] op_sel_hi:[0,1,1] neg_lo:[0,1,0]
    v_pk_fma_f32 v[154:155], v[158:159], v[104:105], v[154:155] op_sel:[1,1,0] op_sel_hi:[0,1,1] neg_lo:[0,1,0]
    v_cvt_pk_bf16_f32 v172, v152, v153
    v_cvt_pk_bf16_f32 v180, v154, v155
    v_pk_mul_f32 v[156:157], v[152:153], v[104:105] op_sel:[0,0] op_sel_hi:[1,0]
    v_pk_mul_f32 v[158:159], v[154:155], v[104:105] op_sel:[0,0] op_sel_hi:[1,0]
    v_pk_fma_f32 v[156:157], v[152:153], v[104:105], v[156:157] op_sel:[1,1,0] op_sel_hi:[0,1,1] neg_lo:[0,1,0]
    v_pk_fma_f32 v[158:159], v[154:155], v[104:105], v[158:159] op_sel:[1,1,0] op_sel_hi:[0,1,1] neg_lo:[0,1,0]
    v_cvt_pk_bf16_f32 v173, v156, v157
    v_cvt_pk_bf16_f32 v181, v158, v159
    v_pk_mul_f32 v[152:153], v[156:157], v[104:105] op_sel:[0,0] op_sel_hi:[1,0]
    v_pk_mul_f32 v[154:155], v[158:159], v[104:105] op_sel:[0,0] op_sel_hi:[1,0]
    v_pk_fma_f32 v[152:153], v[156:157], v[104:105], v[152:153] op_sel:[1,1,0] op_sel_hi:[0,1,1] neg_lo:[0,1,0]
    v_pk_fma_f32 v[154:155], v[158:159], v[104:105], v[154:155] op_sel:[1,1,0] op_sel_hi:[0,1,1] neg_lo:[0,1,0]
    v_cvt_pk_bf16_f32 v174, v152, v153
    v_cvt_pk_bf16_f32 v182, v154, v155
    v_pk_mul_f32 v[156:157], v[152:153], v[104:105] op_sel:[0,0] op_sel_hi:[1,0]
    v_pk_mul_f32 v[158:159], v[154:155], v[104:105] op_sel:[0,0] op_sel_hi:[1,0]
    v_pk_fma_f32 v[156:157], v[152:153], v[104:105], v[156:157] op_sel:[1,1,0] op_sel_hi:[0,1,1] neg_lo:[0,1,0]
    v_pk_fma_f32 v[158:159], v[154:155], v[104:105], v[158:159] op_sel:[1,1,0] op_sel_hi:[0,1,1] neg_lo:[0,1,0]
    v_cvt_pk_bf16_f32 v175, v156, v157
    v_cvt_pk_bf16_f32 v183, v158, v159
    ds_write2_b32 v34, v168, v169 offset0:0 offset1:4
    ds_write2_b32 v34, v170, v171 offset0:8 offset1:12
    ds_write2_b32 v34, v172, v173 offset0:16 offset1:20
    ds_write2_b32 v34, v174, v175 offset0:24 offset1:28
    ds_write2_b32 v34, v176, v177 offset0:32 offset1:36
    ds_write2_b32 v34, v178, v179 offset0:40 offset1:44
    ds_write2_b32 v34, v180, v181 offset0:48 offset1:52
    ds_write2_b32 v34, v182, v183 offset0:56 offset1:60
    ds_read_b128 v[72:75], v35 offset:0
    ds_read_b128 v[76:79], v35 offset:1088
    ds_read_b128 v[80:83], v35 offset:2176
    ds_read_b128 v[84:87], v35 offset:3264
    v_cvt_pk_bf16_f32 v168, v122, v123
    v_cvt_pk_bf16_f32 v172, v124, v125
    v_pk_mul_f32 v[156:157], v[122:123], v[106:107] op_sel:[0,0] op_sel_hi:[1,0]
    v_pk_mul_f32 v[158:159], v[124:125], v[106:107] op_sel:[0,0] op_sel_hi:[1,0]
    v_pk_fma_f32 v[156:157], v[122:123], v[106:107], v[156:157] op_sel:[1,1,0] op_sel_hi:[0,1,1] neg_lo:[0,1,0]
    v_pk_fma_f32 v[158:159], v[124:125], v[106:107], v[158:159] op_sel:[1,1,0] op_sel_hi:[0,1,1] neg_lo:[0,1,0]
    v_cvt_pk_bf16_f32 v169, v156, v157
    v_cvt_pk_bf16_f32 v173, v158, v159
    v_pk_mul_f32 v[152:153], v[156:157], v[106:107] op_sel:[0,0] op_sel_hi:[1,0]
    v_pk_mul_f32 v[154:155], v[158:159], v[106:107] op_sel:[0,0] op_sel_hi:[1,0]
    v_pk_fma_f32 v[152:153], v[156:157], v[106:107], v[152:153] op_sel:[1,1,0] op_sel_hi:[0,1,1] neg_lo:[0,1,0]
    v_pk_fma_f32 v[154:155], v[158:159], v[106:107], v[154:155] op_sel:[1,1,0] op_sel_hi:[0,1,1] neg_lo:[0,1,0]
    v_cvt_pk_bf16_f32 v170, v152, v153
    v_cvt_pk_bf16_f32 v174, v154, v155
    v_pk_mul_f32 v[156:157], v[152:153], v[106:107] op_sel:[0,0] op_sel_hi:[1,0]
    v_pk_mul_f32 v[158:159], v[154:155], v[106:107] op_sel:[0,0] op_sel_hi:[1,0]
    v_pk_fma_f32 v[156:157], v[152:153], v[106:107], v[156:157] op_sel:[1,1,0] op_sel_hi:[0,1,1] neg_lo:[0,1,0]
    v_pk_fma_f32 v[158:159], v[154:155], v[106:107], v[158:159] op_sel:[1,1,0] op_sel_hi:[0,1,1] neg_lo:[0,1,0]
    v_cvt_pk_bf16_f32 v171, v156, v157
    v_cvt_pk_bf16_f32 v175, v158, v159
    v_pk_mul_f32 v[160:161], v[126:127], v[108:109] op_sel:[0,0] op_sel_hi:[1,0]
    v_pk_mul_f32 v[162:163], v[128:129], v[108:109] op_sel:[0,0] op_sel_hi:[1,0]
    v_pk_mul_f32 v[164:165], v[130:131], v[108:109] op_sel:[0,0] op_sel_hi:[1,0]
    v_pk_mul_f32 v[166:167], v[132:133], v[108:109] op_sel:[0,0] op_sel_hi:[1,0]
    v_pk_fma_f32 v[160:161], v[126:127], v[108:109], v[160:161] op_sel:[1,1,0] op_sel_hi:[0,1,1] neg_lo:[0,1,0]
    v_pk_fma_f32 v[162:163], v[128:129], v[108:109], v[162:163] op_sel:[1,1,0] op_sel_hi:[0,1,1] neg_lo:[0,1,0]
    v_pk_fma_f32 v[164:165], v[130:131], v[108:109], v[164:165] op_sel:[1,1,0] op_sel_hi:[0,1,1] neg_lo:[0,1,0]
    v_pk_fma_f32 v[166:167], v[132:133], v[108:109], v[166:167] op_sel:[1,1,0] op_sel_hi:[0,1,1] neg_lo:[0,1,0]
    v_cvt_pk_bf16_f32 v176, v126, v127
    v_cvt_pk_bf16_f32 v177, v160, v161
    v_cvt_pk_bf16_f32 v178, v128, v129
    v_cvt_pk_bf16_f32 v179, v162, v163
    v_cvt_pk_bf16_f32 v180, v130, v131
    v_cvt_pk_bf16_f32 v181, v164, v165
    v_cvt_pk_bf16_f32 v182, v132, v133
    v_cvt_pk_bf16_f32 v183, v166, v167
    ds_write2_b32 v34, v168, v169 offset0:0 offset1:4
    ds_write2_b32 v34, v170, v171 offset0:8 offset1:12
    ds_write2_b32 v34, v172, v173 offset0:16 offset1:20
    ds_write2_b32 v34, v174, v175 offset0:24 offset1:28
    ds_write2_b32 v34, v176, v177 offset0:32 offset1:36
    ds_write2_b32 v34, v178, v179 offset0:40 offset1:44
    ds_write2_b32 v34, v180, v181 offset0:48 offset1:52
    ds_write2_b32 v34, v182, v183 offset0:56 offset1:60
    s_waitcnt lgkmcnt(8)
    v_mfma_f32_16x16x32_bf16 v[44:47], v[72:75], v[56:59], v[44:47]
    v_mfma_f32_16x16x32_bf16 v[44:47], v[76:79], v[60:63], v[44:47]
    v_mfma_f32_16x16x32_bf16 v[44:47], v[80:83], v[64:67], v[44:47]
    v_mfma_f32_16x16x32_bf16 v[44:47], v[84:87], v[68:71], v[44:47]
    ds_read_b128 v[88:91], v35 offset:0
    ds_read_b128 v[92:95], v35 offset:1088
    ds_read_b128 v[96:99], v35 offset:2176
    ds_read_b128 v[100:103], v35 offset:3264
    v_cvt_pk_bf16_f32 v168, v134, v135
    v_cvt_pk_bf16_f32 v169, v136, v137
    v_cvt_pk_bf16_f32 v170, v138, v139
    v_cvt_pk_bf16_f32 v171, v140, v141
    v_cvt_pk_bf16_f32 v172, v142, v143
    v_cvt_pk_bf16_f32 v173, v144, v145
    v_cvt_pk_bf16_f32 v174, v146, v147
    v_cvt_pk_bf16_f32 v175, v148, v149
    v_cvt_pk_bf16_f32 v176, v150, v151
    ds_write2_b32 v34, v168, v169 offset0:0 offset1:4
    ds_write2_b32 v34, v170, v171 offset0:8 offset1:12
    ds_write2_b32 v34, v172, v173 offset0:16 offset1:20
    ds_write2_b32 v34, v174, v175 offset0:24 offset1:28
    ds_write_b32 v34, v176 offset:128
    s_waitcnt lgkmcnt(5)
    v_mfma_f32_16x16x32_bf16 v[48:51], v[88:91], v[56:59], v[48:51]
    v_mfma_f32_16x16x32_bf16 v[48:51], v[92:95], v[60:63], v[48:51]
    v_mfma_f32_16x16x32_bf16 v[48:51], v[96:99], v[64:67], v[48:51]
    v_mfma_f32_16x16x32_bf16 v[48:51], v[100:103], v[68:71], v[48:51]
    ds_read_b128 v[72:75], v35 offset:0
    ds_read_b128 v[76:79], v35 offset:1088
    ds_read_b128 v[80:83], v35 offset:2176
    ds_read_b128 v[84:87], v35 offset:3264
    s_waitcnt lgkmcnt(0)
    v_mfma_f32_16x16x32_bf16 v[52:55], v[72:75], v[56:59], v[52:55]
    v_mfma_f32_16x16x32_bf16 v[52:55], v[76:79], v[60:63], v[52:55]
    v_mfma_f32_16x16x32_bf16 v[52:55], v[80:83], v[64:67], v[52:55]
    v_mfma_f32_16x16x32_bf16 v[52:55], v[84:87], v[68:71], v[52:55]
    s_setprio 0
    s_cmp_lg_u32 s32, 0
    s_cbranch_scc1 ELNS_5
    s_lshr_b32 s50, s3, 5
    s_mul_i32 s50, s50, 4352
    s_lshr_b32 s51, s35, 4
    s_and_b32 s51, s51, 3
    s_lshl_b32 s51, s51, 8
    s_add_u32 s50, s50, s51
    s_add_u32 s50, s50, 1966080
    buffer_load_dword v247, v248, s[20:23], s50 offen sc1
ELNS_5:
    v_add_f32 v44, v44, v41
    s_mul_i32 s36, s32, 4352
    s_add_u32 s36, s36, 50176
    v_lshl_add_u32 v184, v1, 4, s36
    s_xor_b32 s37, s32, 1
    s_mul_i32 s36, s37, 4352
    s_add_u32 s36, s36, 50176
    v_lshl_add_u32 v185, v1, 4, s36
    s_cmp_eq_u32 s34, 1
    s_cbranch_scc1 SSM_X1_6
    ds_write_b128 v184, v[52:55]
    v_mov_b32 v172, v50
    v_mov_b32 v173, v51
    ds_write_b128 v184, v[172:175] offset:1024
    s_waitcnt lgkmcnt(0)
    s_barrier
    ds_read_b128 v[168:171], v185
    ds_read_b128 v[172:175], v185 offset:1024
    s_waitcnt lgkmcnt(0)
    v_add_f32 v44, v44, v168
    v_add_f32 v45, v45, v169
    v_add_f32 v46, v46, v170
    v_add_f32 v47, v47, v171
    v_add_f32 v48, v48, v172
    v_add_f32 v49, v49, v173
    ds_write_b128 v36, v[44:47]
    ds_write_b64 v37, v[48:49]
    s_branch SSM_XE_7
SSM_X1_6:
    ds_write_b128 v184, v[44:47]
    v_mov_b32 v172, v48
    v_mov_b32 v173, v49
    ds_write_b128 v184, v[172:175] offset:1024
    s_waitcnt lgkmcnt(0)
    s_barrier
    ds_read_b128 v[168:171], v185
    ds_read_b128 v[172:175], v185 offset:1024
    s_waitcnt lgkmcnt(0)
    v_add_f32 v52, v52, v168
    v_add_f32 v53, v53, v169
    v_add_f32 v54, v54, v170
    v_add_f32 v55, v55, v171
    v_add_f32 v50, v50, v172
    v_add_f32 v51, v51, v173
    ds_write_b64 v38, v[50:51]
    ds_write2_b32 v39, v52, v53 offset0:0 offset1:16
    ds_write2_b32 v39, v54, v55 offset0:32 offset1:48
SSM_XE_7:
    s_waitcnt lgkmcnt(0)
    s_barrier
    ds_read_b32 v190, v12
    ds_read_b32 v191, v13
    ds_read_b32 v192, v14
    ds_read_b32 v193, v15
    ds_read_b32 v194, v16
    ds_read_b32 v195, v17
    ds_read_b32 v196, v18
    ds_read_b32 v197, v19
    ds_read_b32 v198, v20
    ds_read_b32 v199, v21
    ds_read_b32 v200, v22
    ds_read_b32 v201, v23
    ds_read_b32 v202, v24
    ds_read_b32 v203, v25
    ds_read_b32 v204, v26
    ds_read_b32 v205, v27
    s_mul_i32 s36, s33, 4608
    s_add_u32 s36, s36, 34816
    v_lshl_add_u32 v206, v28, 2, s36
    s_waitcnt lgkmcnt(14)
    v_cvt_pk_bf16_f32 v190, v190, v191
    s_waitcnt lgkmcnt(12)
    v_cvt_pk_bf16_f32 v192, v192, v193
    ds_write2st64_b32 v206, v190, v192 offset0:0 offset1:2
    s_waitcnt lgkmcnt(11)
    v_cvt_pk_bf16_f32 v194, v194, v195
    s_waitcnt lgkmcnt(9)
    v_cvt_pk_bf16_f32 v196, v196, v197
    ds_write2st64_b32 v206, v194, v196 offset0:4 offset1:6
    s_waitcnt lgkmcnt(8)
    v_cvt_pk_bf16_f32 v198, v198, v199
    s_waitcnt lgkmcnt(6)
    v_cvt_pk_bf16_f32 v200, v200, v201
    ds_write2st64_b32 v206, v198, v200 offset0:8 offset1:10
    s_waitcnt lgkmcnt(5)
    v_cvt_pk_bf16_f32 v202, v202, v203
    s_waitcnt lgkmcnt(3)
    v_cvt_pk_bf16_f32 v204, v204, v205
    ds_write2st64_b32 v206, v202, v204 offset0:12 offset1:14
    s_waitcnt lgkmcnt(0)
    s_setprio 3
    s_cmp_lg_u32 s32, 0
    s_cbranch_scc1 SPOLLX_8
    s_waitcnt vmcnt(0)
    v_cmp_eq_u32 s[52:53], 0, v249
    v_cmp_ne_u32 vcc, v247, v249
    s_or_b64 s[52:53], s[52:53], vcc
    s_cmp_eq_u64 s[52:53], 0
    s_cbranch_scc1 SPOLLX_8
    s_lshr_b32 s50, s3, 5
    s_mul_i32 s50, s50, 4352
    s_lshr_b32 s51, s35, 4
    s_and_b32 s51, s51, 3
    s_lshl_b32 s51, s51, 8
    s_add_u32 s50, s50, s51
    s_add_u32 s50, s50, 1966080
    s_mov_b32 s49, 4000
SPOLL_9:
    buffer_load_dword v207, v248, s[20:23], s50 offen sc1
    s_sub_u32 s49, s49, 1
    s_cbranch_scc1 SPOLLD_10
    s_waitcnt vmcnt(0)
    v_cmp_eq_u32 s[52:53], 0, v249
    v_cmp_ne_u32 vcc, v207, v249
    s_cmp_eq_u64 s[52:53], 0
    s_cbranch_scc1 SPOLLN_11
    buffer_load_dword v249, v248, s[44:47], 0 offen sc1
    s_sleep 4
    s_branch SPOLL_9
SPOLLN_11:
    s_cmp_eq_u64 vcc, 0
    s_cbranch_scc1 SPOLLD_10
    s_sleep 4
    s_branch SPOLL_9
SPOLLD_10:
    s_branch SPOLLX_8
SPOLLX_8:
    s_waitcnt vmcnt(0)
    s_barrier
    v_lshlrev_b32 v43, 4, v1
    s_mul_i32 s36, s35, 4224
    s_lshl_b32 s37, s34, 11
    s_add_u32 s36, s36, s37
    s_add_u32 s36, s36, 112
    buffer_load_dwordx4 v[44:47], v43, s[20:23], s36 offen offset:0 sc1
    buffer_load_dwordx4 v[56:59], v43, s[20:23], s36 offen offset:8 sc1
    buffer_load_dwordx4 v[48:51], v43, s[20:23], s36 offen offset:1024 sc1
    buffer_load_dwordx4 v[60:63], v43, s[20:23], s36 offen offset:1032 sc1
    s_mov_b64 exec, 1
    buffer_load_dwordx4 v[52:55], v43, s[20:23], s36 offen offset:2048 sc1
    buffer_load_dwordx4 v[64:67], v43, s[20:23], s36 offen offset:2056 sc1
    s_mov_b64 exec, -1
    v_lshlrev_b32 v68, 6, v1
    s_lshl_b32 s37, s34, 13
    s_add_u32 s37, s37, s41
    s_add_u32 s37, s37, 64
    v_add_u32 v68, s37, v68
    v_add_u32 v2, 1, v1
    v_bfe_u32 v2, v2, 1, 2
    v_lshl_add_u32 v68, v2, 4, v68
    v_xor_b32 v108, 16, v68
    v_xor_b32 v109, 32, v68
    v_xor_b32 v110, 48, v68
    s_waitcnt vmcnt(4)
    v_alignbit_b32 v72, v45, v44, 16
    v_alignbit_b32 v73, v46, v45, 16
    v_alignbit_b32 v74, v47, v46, 16
    v_alignbit_b32 v75, v58, v47, 16
    v_mov_b32 v76, v45
    v_mov_b32 v77, v46
    v_mov_b32 v78, v47
    v_mov_b32 v79, v58
    v_mov_b32 v80, v73
    v_mov_b32 v81, v74
    v_mov_b32 v82, v75
    v_alignbit_b32 v83, v59, v58, 16
    ds_write_b128 v68, v[72:75] offset:0
    ds_write_b128 v108, v[76:79] offset:0
    ds_write_b128 v109, v[80:83] offset:0
    ds_write_b128 v110, v[56:59] offset:0
    s_waitcnt vmcnt(2)
    v_alignbit_b32 v84, v49, v48, 16
    v_alignbit_b32 v85, v50, v49, 16
    v_alignbit_b32 v86, v51, v50, 16
    v_alignbit_b32 v87, v62, v51, 16
    v_mov_b32 v88, v49
    v_mov_b32 v89, v50
    v_mov_b32 v90, v51
    v_mov_b32 v91, v62
    v_mov_b32 v92, v85
    v_mov_b32 v93, v86
    v_mov_b32 v94, v87
    v_alignbit_b32 v95, v63, v62, 16
    ds_write_b128 v68, v[84:87] offset:4096
    ds_write_b128 v108, v[88:91] offset:4096
    ds_write_b128 v109, v[92:95] offset:4096
    ds_write_b128 v110, v[60:63] offset:4096
    s_waitcnt vmcnt(0)
    s_mov_b64 exec, 1
    v_alignbit_b32 v96, v53, v52, 16
    v_alignbit_b32 v97, v54, v53, 16
    v_alignbit_b32 v98, v55, v54, 16
    v_alignbit_b32 v99, v66, v55, 16
    v_mov_b32 v100, v53
    v_mov_b32 v101, v54
    v_mov_b32 v102, v55
    v_mov_b32 v103, v66
    v_mov_b32 v104, v97
    v_mov_b32 v105, v98
    v_mov_b32 v106, v99
    v_alignbit_b32 v107, v67, v66, 16
    ds_write_b128 v68, v[96:99] offset:8192
    ds_write_b128 v108, v[100:103] offset:8192
    ds_write_b128 v109, v[104:107] offset:8192
    ds_write_b128 v110, v[64:67] offset:8192
    s_mov_b64 exec, -1
    v_and_b32 v2, 15, v1
    v_lshrrev_b32 v3, 4, v1
    v_lshl_add_u32 v4, v3, 3, v2
    v_lshrrev_b32 v43, 3, v4
    v_lshlrev_b32 v43, 6, v43
    v_and_b32 v44, 3, v4
    v_lshl_add_u32 v43, v44, 4, v43
    s_lshl_b32 s36, s34, 10
    s_add_u32 s36, s36, s41
    v_add_u32 v43, s36, v43
    v_bfe_u32 v4, v4, 2, 1
    v_mul_u32_u24 v44, 56, v4
    v_lshl_add_u32 v43, v4, 3, v43
    v_mul_u32_u24 v44, 48, v4
    v_add3_u32 v44, v44, v43, 8
    v_lshl_add_u32 v46, v3, 3, v2
    v_lshrrev_b32 v46, 3, v46
    v_add_u32 v47, v46, v4
    v_bfe_u32 v46, v46, 1, 2
    v_bfe_u32 v47, v47, 1, 2
    v_lshlrev_b32 v46, 4, v46
    v_lshlrev_b32 v47, 4, v47
    v_xor_b32 v43, v43, v46
    v_xor_b32 v44, v44, v47
    v_xor_b32 v46, 32, v43
    v_xor_b32 v47, 32, v44
    s_mul_i32 s36, s33, 4608
    s_lshl_b32 s37, s34, 8
    s_add_u32 s36, s36, s37
    s_add_u32 s36, s36, 35296
    v_lshlrev_b32 v2, 5, v2
    v_sub_u32 v45, s36, v2
    v_lshl_add_u32 v45, v3, 4, v45
    v_mov_b32 v48, 0
    v_mov_b32 v49, 0
    v_mov_b32 v50, 0
    v_mov_b32 v51, 0
    v_mov_b32 v52, 0
    v_mov_b32 v53, 0
    v_mov_b32 v54, 0
    v_mov_b32 v55, 0
    v_mov_b32 v56, 0
    v_mov_b32 v57, 0
    v_mov_b32 v58, 0
    v_mov_b32 v59, 0
    v_mov_b32 v60, 0
    v_mov_b32 v61, 0
    v_mov_b32 v62, 0
    v_mov_b32 v63, 0
    v_mov_b32 v64, 0
    v_mov_b32 v65, 0
    v_mov_b32 v66, 0
    v_mov_b32 v67, 0
    v_mov_b32 v68, 0
    v_mov_b32 v69, 0
    v_mov_b32 v70, 0
    v_mov_b32 v71, 0
    v_mov_b32 v72, 0
    v_mov_b32 v73, 0
    v_mov_b32 v74, 0
    v_mov_b32 v75, 0
    v_mov_b32 v76, 0
    v_mov_b32 v77, 0
    v_mov_b32 v78, 0
    v_mov_b32 v79, 0
    s_waitcnt vmcnt(0) lgkmcnt(0)
    s_barrier
    ds_read_b128 v[144:147], v45 offset:0
    ds_read_b64 v[80:81], v43 offset:0
    ds_read_b64 v[82:83], v44 offset:0
    ds_read_b128 v[148:151], v45 offset:512
    ds_read_b64 v[84:85], v43 offset:2048
    ds_read_b64 v[86:87], v44 offset:2048
    ds_read_b128 v[152:155], v45 offset:1024
    ds_read_b64 v[88:89], v43 offset:4096
    ds_read_b64 v[90:91], v44 offset:4096
    ds_read_b128 v[156:159], v45 offset:1536
    ds_read_b64 v[92:93], v43 offset:6144
    ds_read_b64 v[94:95], v44 offset:6144
    ds_read_b128 v[160:163], v45 offset:2048
    ds_read_b64 v[96:97], v43 offset:8192
    ds_read_b64 v[98:99], v44 offset:8192
    ds_read_b128 v[164:167], v45 offset:2560
    ds_read_b64 v[100:101], v43 offset:10240
    ds_read_b64 v[102:103], v44 offset:10240
    ds_read_b128 v[168:171], v45 offset:3072
    ds_read_b64 v[104:105], v43 offset:12288
    ds_read_b64 v[106:107], v44 offset:12288
    ds_read_b128 v[172:175], v45 offset:3584
    ds_read_b64 v[108:109], v43 offset:14336
    ds_read_b64 v[110:111], v44 offset:14336
    s_waitcnt lgkmcnt(0)
    v_mfma_f32_16x16x32_bf16 v[48:51], v[80:83], v[172:175], v[48:51]
    ds_read_b128 v[176:179], v45 offset:64
    v_mfma_f32_16x16x32_bf16 v[52:55], v[80:83], v[168:171], v[52:55]
    ds_read_b64 v[112:113], v46 offset:256
    v_mfma_f32_16x16x32_bf16 v[56:59], v[80:83], v[164:167], v[56:59]
    ds_read_b64 v[114:115], v47 offset:256
    v_mfma_f32_16x16x32_bf16 v[60:63], v[80:83], v[160:163], v[60:63]
    ds_read_b128 v[180:183], v45 offset:576
    v_mfma_f32_16x16x32_bf16 v[64:67], v[80:83], v[156:159], v[64:67]
    ds_read_b64 v[116:117], v46 offset:2304
    v_mfma_f32_16x16x32_bf16 v[68:71], v[80:83], v[152:155], v[68:71]
    ds_read_b64 v[118:119], v47 offset:2304
    v_mfma_f32_16x16x32_bf16 v[72:75], v[80:83], v[148:151], v[72:75]
    ds_read_b128 v[184:187], v45 offset:1088
    v_mfma_f32_16x16x32_bf16 v[76:79], v[80:83], v[144:147], v[76:79]
    ds_read_b64 v[120:121], v46 offset:4352
    v_mfma_f32_16x16x32_bf16 v[52:55], v[84:87], v[172:175], v[52:55]
    ds_read_b64 v[122:123], v47 offset:4352
    v_mfma_f32_16x16x32_bf16 v[56:59], v[84:87], v[168:171], v[56:59]
    ds_read_b128 v[188:191], v45 offset:1600
    v_mfma_f32_16x16x32_bf16 v[60:63], v[84:87], v[164:167], v[60:63]
    ds_read_b64 v[124:125], v46 offset:6400
    v_mfma_f32_16x16x32_bf16 v[64:67], v[84:87], v[160:163], v[64:67]
    ds_read_b64 v[126:127], v47 offset:6400
    v_mfma_f32_16x16x32_bf16 v[68:71], v[84:87], v[156:159], v[68:71]
    ds_read_b128 v[192:195], v45 offset:2112
    v_mfma_f32_16x16x32_bf16 v[72:75], v[84:87], v[152:155], v[72:75]
    ds_read_b64 v[128:129], v46 offset:8448
    v_mfma_f32_16x16x32_bf16 v[76:79], v[84:87], v[148:151], v[76:79]
    ds_read_b64 v[130:131], v47 offset:8448
    v_mfma_f32_16x16x32_bf16 v[56:59], v[88:91], v[172:175], v[56:59]
    ds_read_b128 v[196:199], v45 offset:2624
    v_mfma_f32_16x16x32_bf16 v[60:63], v[88:91], v[168:171], v[60:63]
    ds_read_b64 v[132:133], v46 offset:10496
    v_mfma_f32_16x16x32_bf16 v[64:67], v[88:91], v[164:167], v[64:67]
    ds_read_b64 v[134:135], v47 offset:10496
    v_mfma_f32_16x16x32_bf16 v[68:71], v[88:91], v[160:163], v[68:71]
    ds_read_b128 v[200:203], v45 offset:3136
    v_mfma_f32_16x16x32_bf16 v[72:75], v[88:91], v[156:159], v[72:75]
    ds_read_b64 v[136:137], v46 offset:12544
    v_mfma_f32_16x16x32_bf16 v[76:79], v[88:91], v[152:155], v[76:79]
    ds_read_b64 v[138:139], v47 offset:12544
    v_mfma_f32_16x16x32_bf16 v[60:63], v[92:95], v[172:175], v[60:63]
    ds_read_b128 v[204:207], v45 offset:3648
    v_mfma_f32_16x16x32_bf16 v[64:67], v[92:95], v[168:171], v[64:67]
    ds_read_b64 v[140:141], v46 offset:14592
    v_mfma_f32_16x16x32_bf16 v[68:71], v[92:95], v[164:167], v[68:71]
    ds_read_b64 v[142:143], v47 offset:14592
    v_mfma_f32_16x16x32_bf16 v[72:75], v[92:95], v[160:163], v[72:75]
    v_mfma_f32_16x16x32_bf16 v[76:79], v[92:95], v[156:159], v[76:79]
    v_mfma_f32_16x16x32_bf16 v[64:67], v[96:99], v[172:175], v[64:67]
    v_mfma_f32_16x16x32_bf16 v[68:71], v[96:99], v[168:171], v[68:71]
    v_mfma_f32_16x16x32_bf16 v[72:75], v[96:99], v[164:167], v[72:75]
    v_mfma_f32_16x16x32_bf16 v[76:79], v[96:99], v[160:163], v[76:79]
    v_mfma_f32_16x16x32_bf16 v[68:71], v[100:103], v[172:175], v[68:71]
    v_mfma_f32_16x16x32_bf16 v[72:75], v[100:103], v[168:171], v[72:75]
    v_mfma_f32_16x16x32_bf16 v[76:79], v[100:103], v[164:167], v[76:79]
    v_mfma_f32_16x16x32_bf16 v[72:75], v[104:107], v[172:175], v[72:75]
    v_mfma_f32_16x16x32_bf16 v[76:79], v[104:107], v[168:171], v[76:79]
    v_mfma_f32_16x16x32_bf16 v[76:79], v[108:111], v[172:175], v[76:79]
    s_waitcnt lgkmcnt(0)
    v_mfma_f32_16x16x32_bf16 v[48:51], v[112:115], v[204:207], v[48:51]
    ds_read_b128 v[144:147], v45 offset:128
    v_mfma_f32_16x16x32_bf16 v[52:55], v[112:115], v[200:203], v[52:55]
    ds_read_b64 v[80:81], v43 offset:512
    v_mfma_f32_16x16x32_bf16 v[56:59], v[112:115], v[196:199], v[56:59]
    ds_read_b64 v[82:83], v44 offset:512
    v_mfma_f32_16x16x32_bf16 v[60:63], v[112:115], v[192:195], v[60:63]
    ds_read_b128 v[148:151], v45 offset:640
    v_mfma_f32_16x16x32_bf16 v[64:67], v[112:115], v[188:191], v[64:67]
    ds_read_b64 v[84:85], v43 offset:2560
    v_mfma_f32_16x16x32_bf16 v[68:71], v[112:115], v[184:187], v[68:71]
    ds_read_b64 v[86:87], v44 offset:2560
    v_mfma_f32_16x16x32_bf16 v[72:75], v[112:115], v[180:183], v[72:75]
    ds_read_b128 v[152:155], v45 offset:1152
    v_mfma_f32_16x16x32_bf16 v[76:79], v[112:115], v[176:179], v[76:79]
    ds_read_b64 v[88:89], v43 offset:4608
    v_mfma_f32_16x16x32_bf16 v[52:55], v[116:119], v[204:207], v[52:55]
    ds_read_b64 v[90:91], v44 offset:4608
    v_mfma_f32_16x16x32_bf16 v[56:59], v[116:119], v[200:203], v[56:59]
    ds_read_b128 v[156:159], v45 offset:1664
    v_mfma_f32_16x16x32_bf16 v[60:63], v[116:119], v[196:199], v[60:63]
    ds_read_b64 v[92:93], v43 offset:6656
    v_mfma_f32_16x16x32_bf16 v[64:67], v[116:119], v[192:195], v[64:67]
    ds_read_b64 v[94:95], v44 offset:6656
    v_mfma_f32_16x16x32_bf16 v[68:71], v[116:119], v[188:191], v[68:71]
    ds_read_b128 v[160:163], v45 offset:2176
    v_mfma_f32_16x16x32_bf16 v[72:75], v[116:119], v[184:187], v[72:75]
    ds_read_b64 v[96:97], v43 offset:8704
    v_mfma_f32_16x16x32_bf16 v[76:79], v[116:119], v[180:183], v[76:79]
    ds_read_b64 v[98:99], v44 offset:8704
    v_mfma_f32_16x16x32_bf16 v[56:59], v[120:123], v[204:207], v[56:59]
    ds_read_b128 v[164:167], v45 offset:2688
    v_mfma_f32_16x16x32_bf16 v[60:63], v[120:123], v[200:203], v[60:63]
    ds_read_b64 v[100:101], v43 offset:10752
    v_mfma_f32_16x16x32_bf16 v[64:67], v[120:123], v[196:199], v[64:67]
    ds_read_b64 v[102:103], v44 offset:10752
    v_mfma_f32_16x16x32_bf16 v[68:71], v[120:123], v[192:195], v[68:71]
    ds_read_b128 v[168:171], v45 offset:3200
    v_mfma_f32_16x16x32_bf16 v[72:75], v[120:123], v[188:191], v[72:75]
    ds_read_b64 v[104:105], v43 offset:12800
    v_mfma_f32_16x16x32_bf16 v[76:79], v[120:123], v[184:187], v[76:79]
    ds_read_b64 v[106:107], v44 offset:12800
    v_mfma_f32_16x16x32_bf16 v[60:63], v[124:127], v[204:207], v[60:63]
    ds_read_b128 v[172:175], v45 offset:3712
    v_mfma_f32_16x16x32_bf16 v[64:67], v[124:127], v[200:203], v[64:67]
    ds_read_b64 v[108:109], v43 offset:14848
    v_mfma_f32_16x16x32_bf16 v[68:71], v[124:127], v[196:199], v[68:71]
    ds_read_b64 v[110:111], v44 offset:14848
    v_mfma_f32_16x16x32_bf16 v[72:75], v[124:127], v[192:195], v[72:75]
    v_mfma_f32_16x16x32_bf16 v[76:79], v[124:127], v[188:191], v[76:79]
    v_mfma_f32_16x16x32_bf16 v[64:67], v[128:131], v[204:207], v[64:67]
    v_mfma_f32_16x16x32_bf16 v[68:71], v[128:131], v[200:203], v[68:71]
    v_mfma_f32_16x16x32_bf16 v[72:75], v[128:131], v[196:199], v[72:75]
    v_mfma_f32_16x16x32_bf16 v[76:79], v[128:131], v[192:195], v[76:79]
    v_mfma_f32_16x16x32_bf16 v[68:71], v[132:135], v[204:207], v[68:71]
    v_mfma_f32_16x16x32_bf16 v[72:75], v[132:135], v[200:203], v[72:75]
    v_mfma_f32_16x16x32_bf16 v[76:79], v[132:135], v[196:199], v[76:79]
    v_mfma_f32_16x16x32_bf16 v[72:75], v[136:139], v[204:207], v[72:75]
    v_mfma_f32_16x16x32_bf16 v[76:79], v[136:139], v[200:203], v[76:79]
    v_mfma_f32_16x16x32_bf16 v[76:79], v[140:143], v[204:207], v[76:79]
    s_waitcnt lgkmcnt(0)
    v_mfma_f32_16x16x32_bf16 v[48:51], v[80:83], v[172:175], v[48:51]
    ds_read_b128 v[176:179], v45 offset:192
    v_mfma_f32_16x16x32_bf16 v[52:55], v[80:83], v[168:171], v[52:55]
    ds_read_b64 v[112:113], v46 offset:768
    v_mfma_f32_16x16x32_bf16 v[56:59], v[80:83], v[164:167], v[56:59]
    ds_read_b64 v[114:115], v47 offset:768
    v_mfma_f32_16x16x32_bf16 v[60:63], v[80:83], v[160:163], v[60:63]
    ds_read_b128 v[180:183], v45 offset:704
    v_mfma_f32_16x16x32_bf16 v[64:67], v[80:83], v[156:159], v[64:67]
    ds_read_b64 v[116:117], v46 offset:2816
    v_mfma_f32_16x16x32_bf16 v[68:71], v[80:83], v[152:155], v[68:71]
    ds_read_b64 v[118:119], v47 offset:2816
    v_mfma_f32_16x16x32_bf16 v[72:75], v[80:83], v[148:151], v[72:75]
    ds_read_b128 v[184:187], v45 offset:1216
    v_mfma_f32_16x16x32_bf16 v[76:79], v[80:83], v[144:147], v[76:79]
    ds_read_b64 v[120:121], v46 offset:4864
    v_mfma_f32_16x16x32_bf16 v[52:55], v[84:87], v[172:175], v[52:55]
    ds_read_b64 v[122:123], v47 offset:4864
    v_mfma_f32_16x16x32_bf16 v[56:59], v[84:87], v[168:171], v[56:59]
    ds_read_b128 v[188:191], v45 offset:1728
    v_mfma_f32_16x16x32_bf16 v[60:63], v[84:87], v[164:167], v[60:63]
    ds_read_b64 v[124:125], v46 offset:6912
    v_mfma_f32_16x16x32_bf16 v[64:67], v[84:87], v[160:163], v[64:67]
    ds_read_b64 v[126:127], v47 offset:6912
    v_mfma_f32_16x16x32_bf16 v[68:71], v[84:87], v[156:159], v[68:71]
    ds_read_b128 v[192:195], v45 offset:2240
    v_mfma_f32_16x16x32_bf16 v[72:75], v[84:87], v[152:155], v[72:75]
    ds_read_b64 v[128:129], v46 offset:8960
    v_mfma_f32_16x16x32_bf16 v[76:79], v[84:87], v[148:151], v[76:79]
    ds_read_b64 v[130:131], v47 offset:8960
    v_mfma_f32_16x16x32_bf16 v[56:59], v[88:91], v[172:175], v[56:59]
    ds_read_b128 v[196:199], v45 offset:2752
    v_mfma_f32_16x16x32_bf16 v[60:63], v[88:91], v[168:171], v[60:63]
    ds_read_b64 v[132:133], v46 offset:11008
    v_mfma_f32_16x16x32_bf16 v[64:67], v[88:91], v[164:167], v[64:67]
    ds_read_b64 v[134:135], v47 offset:11008
    v_mfma_f32_16x16x32_bf16 v[68:71], v[88:91], v[160:163], v[68:71]
    ds_read_b128 v[200:203], v45 offset:3264
    v_mfma_f32_16x16x32_bf16 v[72:75], v[88:91], v[156:159], v[72:75]
    ds_read_b64 v[136:137], v46 offset:13056
    v_mfma_f32_16x16x32_bf16 v[76:79], v[88:91], v[152:155], v[76:79]
    ds_read_b64 v[138:139], v47 offset:13056
    v_mfma_f32_16x16x32_bf16 v[60:63], v[92:95], v[172:175], v[60:63]
    ds_read_b128 v[204:207], v45 offset:3776
    v_mfma_f32_16x16x32_bf16 v[64:67], v[92:95], v[168:171], v[64:67]
    ds_read_b64 v[140:141], v46 offset:15104
    v_mfma_f32_16x16x32_bf16 v[68:71], v[92:95], v[164:167], v[68:71]
    ds_read_b64 v[142:143], v47 offset:15104
    v_mfma_f32_16x16x32_bf16 v[72:75], v[92:95], v[160:163], v[72:75]
    v_mfma_f32_16x16x32_bf16 v[76:79], v[92:95], v[156:159], v[76:79]
    v_mfma_f32_16x16x32_bf16 v[64:67], v[96:99], v[172:175], v[64:67]
    v_mfma_f32_16x16x32_bf16 v[68:71], v[96:99], v[168:171], v[68:71]
    v_mfma_f32_16x16x32_bf16 v[72:75], v[96:99], v[164:167], v[72:75]
    v_mfma_f32_16x16x32_bf16 v[76:79], v[96:99], v[160:163], v[76:79]
    v_mfma_f32_16x16x32_bf16 v[68:71], v[100:103], v[172:175], v[68:71]
    v_mfma_f32_16x16x32_bf16 v[72:75], v[100:103], v[168:171], v[72:75]
    v_mfma_f32_16x16x32_bf16 v[76:79], v[100:103], v[164:167], v[76:79]
    v_mfma_f32_16x16x32_bf16 v[72:75], v[104:107], v[172:175], v[72:75]
    v_mfma_f32_16x16x32_bf16 v[76:79], v[104:107], v[168:171], v[76:79]
    v_mfma_f32_16x16x32_bf16 v[76:79], v[108:111], v[172:175], v[76:79]
    s_waitcnt lgkmcnt(0)
    v_mfma_f32_16x16x32_bf16 v[48:51], v[112:115], v[204:207], v[48:51]
    v_mfma_f32_16x16x32_bf16 v[52:55], v[112:115], v[200:203], v[52:55]
    v_mfma_f32_16x16x32_bf16 v[56:59], v[112:115], v[196:199], v[56:59]
    v_mfma_f32_16x16x32_bf16 v[60:63], v[112:115], v[192:195], v[60:63]
    v_mfma_f32_16x16x32_bf16 v[64:67], v[112:115], v[188:191], v[64:67]
    v_mfma_f32_16x16x32_bf16 v[68:71], v[112:115], v[184:187], v[68:71]
    v_mfma_f32_16x16x32_bf16 v[72:75], v[112:115], v[180:183], v[72:75]
    v_mfma_f32_16x16x32_bf16 v[76:79], v[112:115], v[176:179], v[76:79]
    v_mfma_f32_16x16x32_bf16 v[52:55], v[116:119], v[204:207], v[52:55]
    v_mfma_f32_16x16x32_bf16 v[56:59], v[116:119], v[200:203], v[56:59]
    v_mfma_f32_16x16x32_bf16 v[60:63], v[116:119], v[196:199], v[60:63]
    v_mfma_f32_16x16x32_bf16 v[64:67], v[116:119], v[192:195], v[64:67]
    v_mfma_f32_16x16x32_bf16 v[68:71], v[116:119], v[188:191], v[68:71]
    v_mfma_f32_16x16x32_bf16 v[72:75], v[116:119], v[184:187], v[72:75]
    v_mfma_f32_16x16x32_bf16 v[76:79], v[116:119], v[180:183], v[76:79]
    v_mfma_f32_16x16x32_bf16 v[56:59], v[120:123], v[204:207], v[56:59]
    v_mfma_f32_16x16x32_bf16 v[60:63], v[120:123], v[200:203], v[60:63]
    v_mfma_f32_16x16x32_bf16 v[64:67], v[120:123], v[196:199], v[64:67]
    v_mfma_f32_16x16x32_bf16 v[68:71], v[120:123], v[192:195], v[68:71]
    v_mfma_f32_16x16x32_bf16 v[72:75], v[120:123], v[188:191], v[72:75]
    v_mfma_f32_16x16x32_bf16 v[76:79], v[120:123], v[184:187], v[76:79]
    v_mfma_f32_16x16x32_bf16 v[60:63], v[124:127], v[204:207], v[60:63]
    v_mfma_f32_16x16x32_bf16 v[64:67], v[124:127], v[200:203], v[64:67]
    v_mfma_f32_16x16x32_bf16 v[68:71], v[124:127], v[196:199], v[68:71]
    v_mfma_f32_16x16x32_bf16 v[72:75], v[124:127], v[192:195], v[72:75]
    v_mfma_f32_16x16x32_bf16 v[76:79], v[124:127], v[188:191], v[76:79]
    v_mfma_f32_16x16x32_bf16 v[64:67], v[128:131], v[204:207], v[64:67]
    v_mfma_f32_16x16x32_bf16 v[68:71], v[128:131], v[200:203], v[68:71]
    v_mfma_f32_16x16x32_bf16 v[72:75], v[128:131], v[196:199], v[72:75]
    v_mfma_f32_16x16x32_bf16 v[76:79], v[128:131], v[192:195], v[76:79]
    v_mfma_f32_16x16x32_bf16 v[68:71], v[132:135], v[204:207], v[68:71]
    v_mfma_f32_16x16x32_bf16 v[72:75], v[132:135], v[200:203], v[72:75]
    v_mfma_f32_16x16x32_bf16 v[76:79], v[132:135], v[196:199], v[76:79]
    v_mfma_f32_16x16x32_bf16 v[72:75], v[136:139], v[204:207], v[72:75]
    v_mfma_f32_16x16x32_bf16 v[76:79], v[136:139], v[200:203], v[76:79]
    v_mfma_f32_16x16x32_bf16 v[76:79], v[140:143], v[204:207], v[76:79]
    v_readfirstlane_b32 s48, v249
    s_cmp_lg_u32 s48, 0
    s_cbranch_scc1 SNON_12
    buffer_load_dword v249, v248, s[44:47], 0 offen sc1
    s_waitcnt vmcnt(0)
    v_readfirstlane_b32 s48, v249
SNON_12:
    s_mul_i32 s36, s32, 4352
    s_add_u32 s36, s36, 50176
    v_lshl_add_u32 v208, v1, 4, s36
    s_xor_b32 s37, s32, 1
    s_mul_i32 s36, s37, 4352
    s_add_u32 s36, s36, 50176
    v_lshl_add_u32 v209, v1, 4, s36
    v_and_b32 v2, 15, v1
    v_lshlrev_b32 v210, 5, v2
    v_bfe_u32 v2, v1, 4, 1
    v_lshl_add_u32 v210, v2, 9, v210
    v_lshrrev_b32 v2, 5, v1
    v_lshl_add_u32 v210, v2, 4, v210
    s_lshl_b32 s36, s35, 12
    s_lshl_b32 s37, s34, 11
    s_add_u32 s36, s36, s37
    s_add_u32 s36, s36, 4194304
    s_cmp_eq_u32 s34, 1
    s_cbranch_scc1 SSM_H1_13
    ds_write_b128 v208, v[64:67] offset:0
    ds_write_b128 v208, v[68:71] offset:1024
    ds_write_b128 v208, v[72:75] offset:2048
    ds_write_b128 v208, v[76:79] offset:3072
    s_waitcnt lgkmcnt(0)
    s_barrier
    ds_read_b128 v[80:83], v209 offset:0
    ds_read_b128 v[84:87], v209 offset:1024
    ds_read_b128 v[88:91], v209 offset:2048
    ds_read_b128 v[92:95], v209 offset:3072
    s_waitcnt lgkmcnt(3)
    v_add_f32 v80, v80, v48
    v_add_f32 v81, v81, v49
    v_add_f32 v82, v82, v50
    v_add_f32 v83, v83, v51
    v_cvt_pk_bf16_f32 v112, v80, v81
    v_cvt_pk_bf16_f32 v113, v82, v83
    s_waitcnt lgkmcnt(2)
    v_add_f32 v84, v84, v52
    v_add_f32 v85, v85, v53
    v_add_f32 v86, v86, v54
    v_add_f32 v87, v87, v55
    v_cvt_pk_bf16_f32 v114, v84, v85
    v_cvt_pk_bf16_f32 v115, v86, v87
    s_waitcnt lgkmcnt(1)
    v_add_f32 v88, v88, v56
    v_add_f32 v89, v89, v57
    v_add_f32 v90, v90, v58
    v_add_f32 v91, v91, v59
    v_cvt_pk_bf16_f32 v116, v88, v89
    v_cvt_pk_bf16_f32 v117, v90, v91
    s_waitcnt lgkmcnt(0)
    v_add_f32 v92, v92, v60
    v_add_f32 v93, v93, v61
    v_add_f32 v94, v94, v62
    v_add_f32 v95, v95, v63
    v_cvt_pk_bf16_f32 v118, v92, v93
    v_cvt_pk_bf16_f32 v119, v94, v95
    s_branch SSM_RE_14
SSM_H1_13:
    ds_write_b128 v208, v[48:51] offset:0
    ds_write_b128 v208, v[52:55] offset:1024
    ds_write_b128 v208, v[56:59] offset:2048
    ds_write_b128 v208, v[60:63] offset:3072
    s_waitcnt lgkmcnt(0)
    s_barrier
    ds_read_b128 v[80:83], v209 offset:0
    ds_read_b128 v[84:87], v209 offset:1024
    ds_read_b128 v[88:91], v209 offset:2048
    ds_read_b128 v[92:95], v209 offset:3072
    s_waitcnt lgkmcnt(3)
    v_add_f32 v80, v80, v64
    v_add_f32 v81, v81, v65
    v_add_f32 v82, v82, v66
    v_add_f32 v83, v83, v67
    v_cvt_pk_bf16_f32 v112, v80, v81
    v_cvt_pk_bf16_f32 v113, v82, v83
    s_waitcnt lgkmcnt(2)
    v_add_f32 v84, v84, v68
    v_add_f32 v85, v85, v69
    v_add_f32 v86, v86, v70
    v_add_f32 v87, v87, v71
    v_cvt_pk_bf16_f32 v114, v84, v85
    v_cvt_pk_bf16_f32 v115, v86, v87
    s_waitcnt lgkmcnt(1)
    v_add_f32 v88, v88, v72
    v_add_f32 v89, v89, v73
    v_add_f32 v90, v90, v74
    v_add_f32 v91, v91, v75
    v_cvt_pk_bf16_f32 v116, v88, v89
    v_cvt_pk_bf16_f32 v117, v90, v91
    s_waitcnt lgkmcnt(0)
    v_add_f32 v92, v92, v76
    v_add_f32 v93, v93, v77
    v_add_f32 v94, v94, v78
    v_add_f32 v95, v95, v79
    v_cvt_pk_bf16_f32 v118, v92, v93
    v_cvt_pk_bf16_f32 v119, v94, v95
SSM_RE_14:
    v_permlane16_swap_b32 v112, v114
    v_permlane16_swap_b32 v113, v115
    v_permlane16_swap_b32 v116, v118
    v_permlane16_swap_b32 v117, v119
    buffer_store_dwordx4 v[112:115], v210, s[20:23], s36 offen offset:0 sc1
    buffer_store_dwordx4 v[116:119], v210, s[20:23], s36 offen offset:1024 sc1
    v_mov_b32 v211, 0
    v_mov_b32 v212, s48
    s_lshr_b32 s50, s35, 6
    s_lshl_b32 s50, s50, 1
    s_add_u32 s50, s50, s34
    s_mul_i32 s50, s50, 2304
    s_and_b32 s51, s35, 63
    s_lshl_b32 s51, s51, 2
    s_add_u32 s50, s50, s51
    s_add_u32 s50, s50, 2048000
    s_waitcnt vmcnt(0)
    s_mov_b64 exec, 1
    buffer_store_dword v212, v211, s[20:23], s50 offen sc1
    s_mov_b64 exec, -1
    s_endpgm
K_MLP:
    s_load_dwordx2 s[4:5], s[0:1], 0
    s_load_dwordx2 s[8:9], s[0:1], 64
    s_load_dwordx2 s[12:13], s[0:1], 112
    s_load_dwordx2 s[16:17], s[0:1], 72
    s_load_dwordx2 s[20:21], s[0:1], 80
    s_load_dwordx2 s[24:25], s[0:1], 96
    s_load_dwordx2 s[28:29], s[0:1], 88
    s_load_dwordx2 s[52:53], s[0:1], 104
    s_and_b32 s35, s3, 7
    s_lshr_b32 s37, s3, 3
    s_mul_i32 s36, s37, 37
    s_lshr_b32 s36, s36, 8
    s_mul_i32 s33, s36, 7
    s_sub_u32 s37, s37, s33
    s_lshr_b32 s33, s35, 1
    s_lshl_b32 s33, s33, 2
    s_add_u32 s33, s33, s36
    s_and_b32 s34, s35, 1
    s_mul_i32 s34, s34, 7
    s_add_u32 s34, s34, s37
    s_lshr_b32 s33, s36, 1
    s_lshl_b32 s34, s35, 1
    s_add_u32 s33, s33, s34
    s_and_b32 s34, s36, 1
    s_mul_i32 s34, s34, 7
    s_add_u32 s34, s34, s37
    v_and_b32 v1, 63, v0
    v_lshrrev_b32 v2, 6, v0
    s_nop 0
    v_readfirstlane_b32 s32, v2
    s_and_b32 s50, s32, 1
    s_lshr_b32 s51, s32, 1
    v_lshrrev_b32 v2, 3, v1
    v_mul_u32_u24 v5, 896, v2
    v_lshrrev_b32 v2, 4, v1
    v_and_b32 v3, 7, v1
    v_xor_b32 v3, v2, v3
    v_xor_b32 v4, 4, v3
    v_lshl_add_u32 v6, v4, 4, v5
    v_lshl_add_u32 v5, v3, 4, v5
    v_add_u32 v6, 6144, v6
    v_add_u32 v7, 12288, v5
    v_add_u32 v8, 12288, v6
    s_lshl_b32 s45, s33, 7
    s_lshl_b32 s46, s32, 5
    s_add_u32 s45, s45, s46
    s_mul_i32 s40, s45, 896
    v_mul_u32_u24 v4, 3584, v2
    v_lshlrev_b32 v9, 2, v2
    v_and_b32 v3, 15, v1
    v_xor_b32 v3, v9, v3
    v_lshl_add_u32 v9, v3, 4, v4
    v_add_u32 v10, 13312, v9
    s_mul_i32 s41, s32, 28672
    s_lshl_b32 s45, s34, 8
    s_add_u32 s41, s41, s45
    s_lshl_b32 s42, s32, 12
    s_lshl_b32 s57, s32, 11
    s_add_u32 s57, s57, 49152
    s_lshr_b32 s45, s36, 1
    s_mul_i32 s45, s45, 0
    s_and_b32 s46, s36, 1
    s_mul_i32 s46, s46, 0
    s_add_u32 s45, s45, s46
    s_add_u32 s45, s45, s37
    s_mul_i32 s46, s35, 1
    s_add_u32 s45, s45, s46
    s_mul_i32 s46, s45, 37
    s_lshr_b32 s46, s46, 8
    s_mul_i32 s46, s46, 7
    s_sub_u32 s45, s45, s46
    s_cmp_ge_u32 s45, 7
    s_cselect_b32 s46, 7, 0
    s_sub_u32 s45, s45, s46
    s_lshl_b32 s46, s45, 7
    s_add_u32 s43, s40, s46
    s_add_u32 s63, s40, 896
    s_mul_i32 s46, s45, 229376
    s_add_u32 s44, s41, s46
    s_waitcnt lgkmcnt(0)
    s_mov_b32 s6, 1835008
    s_mov_b32 s7, 0x00020000
    s_mov_b32 s10, 1605632
    s_mov_b32 s11, 0x00020000
    s_mov_b32 s14, 14680064
    s_mov_b32 s15, 0x00020000
    s_mov_b32 s18, 3584
    s_mov_b32 s19, 0x00020000
    s_mov_b32 s22, 1605632
    s_mov_b32 s23, 0x00020000
    s_mov_b32 s26, 1835008
    s_mov_b32 s27, 0x00020000
    s_mov_b32 s30, 896
    s_mov_b32 s31, 0x00020000
    s_mov_b32 s54, 256
    s_mov_b32 s55, 0x00020000
    v_and_b32 v2, 31, v1
    v_lshlrev_b32 v2, 1, v2
    s_lshl_b32 s45, s34, 8
    s_lshl_b32 s46, s50, 7
    s_add_u32 s45, s45, s46
    s_mov_b32 m0, s42
    s_nop 0
    buffer_load_dwordx4 v5, s[4:7], s43 offen lds
    buffer_load_dwordx4 v6, s[4:7], s43 offen offset:1024 lds
    s_mov_b32 m0, s57
    s_nop 0
    buffer_load_dwordx4 v9, s[8:11], s44 offen lds
    buffer_load_dwordx4 v10, s[8:11], s44 offen offset:1024 lds
    s_add_u32 s44, s44, 114688
    s_cmp_ge_u32 s44, 1605632
    s_cselect_b32 s44, s41, s44
    s_mov_b32 m0, s42
    s_nop 0
    buffer_load_dwordx4 v7, s[4:7], s43 offen offset:2048 lds
    buffer_load_dwordx4 v8, s[4:7], s43 offen offset:3072 lds
    s_add_u32 s43, s43, 128
    s_cmp_eq_u32 s43, s63
    s_cselect_b32 s43, s40, s43
    s_add_u32 m0, s57, 8192
    s_nop 0
    buffer_load_dwordx4 v9, s[8:11], s44 offen lds
    buffer_load_dwordx4 v10, s[8:11], s44 offen offset:1024 lds
    s_add_u32 s44, s44, 114688
    s_cmp_ge_u32 s44, 1605632
    s_cselect_b32 s44, s41, s44
    s_lshl_b32 s45, s34, 8
    s_lshl_b32 s46, s50, 7
    s_add_u32 s45, s45, s46
    buffer_load_ushort v12, v2, s[16:19], s45 offen
    buffer_load_ushort v13, v2, s[16:19], s45 offen offset:64
    v_and_b32 v20, 31, v1
    v_lshrrev_b32 v21, 5, v1
    v_bfe_u32 v2, v20, 1, 3
    v_xor_b32 v2, v2, v21
    s_lshl_b32 s45, s51, 13
    v_lshl_add_u32 v3, v20, 7, s45
    v_lshl_add_u32 v14, v2, 4, v3
    v_xor_b32 v15, 32, v14
    v_xor_b32 v16, 64, v14
    v_xor_b32 v17, 96, v14
    v_bfe_u32 v22, v1, 2, 2
    v_lshl_add_u32 v2, v21, 3, v22
    v_lshlrev_b32 v2, 8, v2
    v_bfe_u32 v3, v1, 4, 1
    v_lshl_add_u32 v2, v3, 5, v2
    v_and_b32 v3, 3, v1
    v_lshl_add_u32 v2, v3, 3, v2
    v_add_u32 v2, 49152, v2
    s_lshl_b32 s45, s50, 1
    v_xor_b32 v3, s45, v22
    v_lshl_add_u32 v18, v3, 6, v2
    v_xor_b32 v19, 64, v18
    v_lshlrev_b32 v182, 2, v1
    v_mov_b32 v24, 0
    v_mov_b32 v25, 0
    v_mov_b32 v26, 0
    v_mov_b32 v27, 0
    v_mov_b32 v28, 0
    v_mov_b32 v29, 0
    v_mov_b32 v30, 0
    v_mov_b32 v31, 0
    v_mov_b32 v32, 0
    v_mov_b32 v33, 0
    v_mov_b32 v34, 0
    v_mov_b32 v35, 0
    v_mov_b32 v36, 0
    v_mov_b32 v37, 0
    v_mov_b32 v38, 0
    v_mov_b32 v39, 0
    v_mov_b32 v40, 0
    v_mov_b32 v41, 0
    v_mov_b32 v42, 0
    v_mov_b32 v43, 0
    v_mov_b32 v44, 0
    v_mov_b32 v45, 0
    v_mov_b32 v46, 0
    v_mov_b32 v47, 0
    v_mov_b32 v48, 0
    v_mov_b32 v49, 0
    v_mov_b32 v50, 0
    v_mov_b32 v51, 0
    v_mov_b32 v52, 0
    v_mov_b32 v53, 0
    v_mov_b32 v54, 0
    v_mov_b32 v55, 0
    v_mov_b32 v56, 0
    v_mov_b32 v57, 0
    v_mov_b32 v58, 0
    v_mov_b32 v59, 0
    v_mov_b32 v60, 0
    v_mov_b32 v61, 0
    v_mov_b32 v62, 0
    v_mov_b32 v63, 0
    v_mov_b32 v64, 0
    v_mov_b32 v65, 0
    v_mov_b32 v66, 0
    v_mov_b32 v67, 0
    v_mov_b32 v68, 0
    v_mov_b32 v69, 0
    v_mov_b32 v70, 0
    v_mov_b32 v71, 0
    v_mov_b32 v72, 0
    v_mov_b32 v73, 0
    v_mov_b32 v74, 0
    v_mov_b32 v75, 0
    v_mov_b32 v76, 0
    v_mov_b32 v77, 0
    v_mov_b32 v78, 0
    v_mov_b32 v79, 0
    v_mov_b32 v80, 0
    v_mov_b32 v81, 0
    v_mov_b32 v82, 0
    v_mov_b32 v83, 0
    v_mov_b32 v84, 0
    v_mov_b32 v85, 0
    v_mov_b32 v86, 0
    v_mov_b32 v87, 0
    v_mov_b32 v152, 0
    v_mov_b32 v153, 0
    v_mov_b32 v154, 0
    v_mov_b32 v155, 0
    v_mov_b32 v156, 0
    v_mov_b32 v157, 0
    v_mov_b32 v158, 0
    v_mov_b32 v159, 0
    v_and_b32 v2, 15, v1
    v_bfe_u32 v3, v1, 4, 1
    v_cmp_eq_u32 vcc, v2, v3
    v_mov_b32 v2, 0x3f803f80
    s_nop 0
    v_cndmask_b32 v160, 0, v2, vcc
    v_cndmask_b32 v161, 0, v2, vcc
    v_cndmask_b32 v162, 0, v2, vcc
    v_cndmask_b32 v163, 0, v2, vcc
    v_lshlrev_b32 v180, 5, v20
    s_add_u32 m0, s42, 16384
    s_nop 0
    buffer_load_dwordx4 v5, s[4:7], s43 offen lds
    buffer_load_dwordx4 v6, s[4:7], s43 offen offset:1024 lds
    s_add_u32 m0, s57, 16384
    s_nop 0
    buffer_load_dwordx4 v9, s[8:11], s44 offen lds
    buffer_load_dwordx4 v10, s[8:11], s44 offen offset:1024 lds
    s_add_u32 s44, s44, 114688
    s_cmp_ge_u32 s44, 1605632
    s_cselect_b32 s44, s41, s44
    s_add_u32 m0, s42, 16384
    s_nop 0
    buffer_load_dwordx4 v7, s[4:7], s43 offen offset:2048 lds
    buffer_load_dwordx4 v8, s[4:7], s43 offen offset:3072 lds
    s_add_u32 s43, s43, 128
    s_cmp_eq_u32 s43, s63
    s_cselect_b32 s43, s40, s43
    s_waitcnt vmcnt(10)
    s_barrier
    ds_read_b128 v[120:123], v14 offset:0
    ds_read_b64_tr_b16 v[88:89], v18 offset:0
    ds_read_b64_tr_b16 v[90:91], v18 offset:1024
    s_add_u32 m0, s57, 24576
    s_nop 0
    buffer_load_dwordx4 v9, s[8:11], s44 offen lds
    ds_read_b128 v[128:131], v14 offset:4096
    ds_read_b64_tr_b16 v[96:97], v19 offset:0
    ds_read_b64_tr_b16 v[98:99], v19 offset:1024
    ds_read_b128 v[124:127], v15 offset:0
    ds_read_b64_tr_b16 v[92:93], v18 offset:4096
    ds_read_b64_tr_b16 v[94:95], v18 offset:5120
    buffer_load_dwordx4 v10, s[8:11], s44 offen offset:1024 lds
    s_add_u32 m0, s42, 32768
    ds_read_b128 v[132:135], v15 offset:4096
    ds_read_b64_tr_b16 v[100:101], v19 offset:4096
    ds_read_b64_tr_b16 v[102:103], v19 offset:5120
    buffer_load_dwordx4 v5, s[4:7], s43 offen lds
    s_add_u32 s44, s44, 114688
    s_cmp_ge_u32 s44, 1605632
    s_cselect_b32 s44, s41, s44
    buffer_load_dwordx4 v6, s[4:7], s43 offen offset:1024 lds
    s_waitcnt lgkmcnt(0)
    v_mfma_f32_32x32x16_bf16 v[24:39], v[88:91], v[120:123], v[24:39]
    s_waitcnt vmcnt(12)
    s_barrier
    v_mfma_f32_32x32x16_bf16 v[40:55], v[88:91], v[128:131], v[40:55]
    ds_read_b128 v[136:139], v16 offset:0
    ds_read_b64_tr_b16 v[104:105], v18 offset:8192
    ds_read_b64_tr_b16 v[106:107], v18 offset:9216
    s_mov_b32 m0, s57
    v_mfma_f32_32x32x16_bf16 v[56:71], v[96:99], v[120:123], v[56:71]
    buffer_load_dwordx4 v9, s[8:11], s44 offen lds
    ds_read_b128 v[144:147], v16 offset:4096
    ds_read_b64_tr_b16 v[112:113], v19 offset:8192
    v_mfma_f32_32x32x16_bf16 v[72:87], v[96:99], v[128:131], v[72:87]
    ds_read_b64_tr_b16 v[114:115], v19 offset:9216
    ds_read_b128 v[140:143], v17 offset:0
    ds_read_b64_tr_b16 v[108:109], v18 offset:12288
    v_mfma_f32_16x16x32_bf16 v[152:155], v[160:163], v[88:91], v[152:155]
    ds_read_b64_tr_b16 v[110:111], v18 offset:13312
    v_mfma_f32_16x16x32_bf16 v[156:159], v[160:163], v[96:99], v[156:159]
    buffer_load_dwordx4 v10, s[8:11], s44 offen offset:1024 lds
    v_mfma_f32_32x32x16_bf16 v[24:39], v[92:95], v[124:127], v[24:39]
    s_add_u32 m0, s42, 32768
    ds_read_b128 v[148:151], v17 offset:4096
    ds_read_b64_tr_b16 v[116:117], v19 offset:12288
    ds_read_b64_tr_b16 v[118:119], v19 offset:13312
    v_mfma_f32_32x32x16_bf16 v[40:55], v[92:95], v[132:135], v[40:55]
    buffer_load_dwordx4 v7, s[4:7], s43 offen offset:2048 lds
    s_add_u32 s44, s44, 114688
    s_cmp_ge_u32 s44, 1605632
    v_mfma_f32_32x32x16_bf16 v[56:71], v[100:103], v[124:127], v[56:71]
    s_cselect_b32 s44, s41, s44
    v_mfma_f32_32x32x16_bf16 v[72:87], v[100:103], v[132:135], v[72:87]
    buffer_load_dwordx4 v8, s[4:7], s43 offen offset:3072 lds
    v_mfma_f32_16x16x32_bf16 v[152:155], v[160:163], v[92:95], v[152:155]
    s_add_u32 s43, s43, 128
    s_cmp_eq_u32 s43, s63
    v_mfma_f32_16x16x32_bf16 v[156:159], v[160:163], v[100:103], v[156:159]
    s_cselect_b32 s43, s40, s43
    s_waitcnt lgkmcnt(0)
    v_mfma_f32_32x32x16_bf16 v[24:39], v[104:107], v[136:139], v[24:39]
    s_waitcnt vmcnt(8)
    s_barrier
    v_mfma_f32_32x32x16_bf16 v[40:55], v[104:107], v[144:147], v[40:55]
    ds_read_b128 v[120:123], v14 offset:16384
    ds_read_b64_tr_b16 v[88:89], v18 offset:16384
    ds_read_b64_tr_b16 v[90:91], v18 offset:17408
    s_add_u32 m0, s57, 8192
    v_mfma_f32_32x32x16_bf16 v[56:71], v[112:115], v[136:139], v[56:71]
    buffer_load_dwordx4 v9, s[8:11], s44 offen lds
    ds_read_b128 v[128:131], v14 offset:20480
    ds_read_b64_tr_b16 v[96:97], v19 offset:16384
    v_mfma_f32_32x32x16_bf16 v[72:87], v[112:115], v[144:147], v[72:87]
    ds_read_b64_tr_b16 v[98:99], v19 offset:17408
    ds_read_b128 v[124:127], v15 offset:16384
    ds_read_b64_tr_b16 v[92:93], v18 offset:20480
    v_mfma_f32_16x16x32_bf16 v[152:155], v[160:163], v[104:107], v[152:155]
    ds_read_b64_tr_b16 v[94:95], v18 offset:21504
    v_mfma_f32_16x16x32_bf16 v[156:159], v[160:163], v[112:115], v[156:159]
    buffer_load_dwordx4 v10, s[8:11], s44 offen offset:1024 lds
    v_mfma_f32_32x32x16_bf16 v[24:39], v[108:111], v[140:143], v[24:39]
    s_mov_b32 m0, s42
    ds_read_b128 v[132:135], v15 offset:20480
    ds_read_b64_tr_b16 v[100:101], v19 offset:20480
    ds_read_b64_tr_b16 v[102:103], v19 offset:21504
    v_mfma_f32_32x32x16_bf16 v[40:55], v[108:111], v[148:151], v[40:55]
    buffer_load_dwordx4 v5, s[4:7], s43 offen lds
    s_add_u32 s44, s44, 114688
    s_cmp_ge_u32 s44, 1605632
    v_mfma_f32_32x32x16_bf16 v[56:71], v[116:119], v[140:143], v[56:71]
    s_cselect_b32 s44, s41, s44
    v_mfma_f32_32x32x16_bf16 v[72:87], v[116:119], v[148:151], v[72:87]
    buffer_load_dwordx4 v6, s[4:7], s43 offen offset:1024 lds
    v_mfma_f32_16x16x32_bf16 v[152:155], v[160:163], v[108:111], v[152:155]
    v_mfma_f32_16x16x32_bf16 v[156:159], v[160:163], v[116:119], v[156:159]
    s_waitcnt lgkmcnt(0)
    v_mfma_f32_32x32x16_bf16 v[24:39], v[88:91], v[120:123], v[24:39]
    s_waitcnt vmcnt(10)
    s_barrier
    v_mfma_f32_32x32x16_bf16 v[40:55], v[88:91], v[128:131], v[40:55]
    ds_read_b128 v[136:139], v16 offset:16384
    ds_read_b64_tr_b16 v[104:105], v18 offset:24576
    ds_read_b64_tr_b16 v[106:107], v18 offset:25600
    s_add_u32 m0, s57, 16384
    v_mfma_f32_32x32x16_bf16 v[56:71], v[96:99], v[120:123], v[56:71]
    buffer_load_dwordx4 v9, s[8:11], s44 offen lds
    ds_read_b128 v[144:147], v16 offset:20480
    ds_read_b64_tr_b16 v[112:113], v19 offset:24576
    v_mfma_f32_32x32x16_bf16 v[72:87], v[96:99], v[128:131], v[72:87]
    ds_read_b64_tr_b16 v[114:115], v19 offset:25600
    ds_read_b128 v[140:143], v17 offset:16384
    ds_read_b64_tr_b16 v[108:109], v18 offset:28672
    v_mfma_f32_16x16x32_bf16 v[152:155], v[160:163], v[88:91], v[152:155]
    ds_read_b64_tr_b16 v[110:111], v18 offset:29696
    v_mfma_f32_16x16x32_bf16 v[156:159], v[160:163], v[96:99], v[156:159]
    buffer_load_dwordx4 v10, s[8:11], s44 offen offset:1024 lds
    v_mfma_f32_32x32x16_bf16 v[24:39], v[92:95], v[124:127], v[24:39]
    s_mov_b32 m0, s42
    ds_read_b128 v[148:151], v17 offset:20480
    ds_read_b64_tr_b16 v[116:117], v19 offset:28672
    ds_read_b64_tr_b16 v[118:119], v19 offset:29696
    v_mfma_f32_32x32x16_bf16 v[40:55], v[92:95], v[132:135], v[40:55]
    buffer_load_dwordx4 v7, s[4:7], s43 offen offset:2048 lds
    s_add_u32 s44, s44, 114688
    s_cmp_ge_u32 s44, 1605632
    v_mfma_f32_32x32x16_bf16 v[56:71], v[100:103], v[124:127], v[56:71]
    s_cselect_b32 s44, s41, s44
    v_mfma_f32_32x32x16_bf16 v[72:87], v[100:103], v[132:135], v[72:87]
    buffer_load_dwordx4 v8, s[4:7], s43 offen offset:3072 lds
    v_mfma_f32_16x16x32_bf16 v[152:155], v[160:163], v[92:95], v[152:155]
    s_add_u32 s43, s43, 128
    s_cmp_eq_u32 s43, s63
    v_mfma_f32_16x16x32_bf16 v[156:159], v[160:163], v[100:103], v[156:159]
    s_cselect_b32 s43, s40, s43
    s_waitcnt lgkmcnt(0)
    v_mfma_f32_32x32x16_bf16 v[24:39], v[104:107], v[136:139], v[24:39]
    s_waitcnt vmcnt(8)
    s_barrier
    v_mfma_f32_32x32x16_bf16 v[40:55], v[104:107], v[144:147], v[40:55]
    ds_read_b128 v[120:123], v14 offset:32768
    ds_read_b64_tr_b16 v[88:89], v18 offset:0
    ds_read_b64_tr_b16 v[90:91], v18 offset:1024
    s_add_u32 m0, s57, 24576
    v_mfma_f32_32x32x16_bf16 v[56:71], v[112:115], v[136:139], v[56:71]
    buffer_load_dwordx4 v9, s[8:11], s44 offen lds
    ds_read_b128 v[128:131], v14 offset:36864
    ds_read_b64_tr_b16 v[96:97], v19 offset:0
    v_mfma_f32_32x32x16_bf16 v[72:87], v[112:115], v[144:147], v[72:87]
    ds_read_b64_tr_b16 v[98:99], v19 offset:1024
    ds_read_b128 v[124:127], v15 offset:32768
    ds_read_b64_tr_b16 v[92:93], v18 offset:4096
    v_mfma_f32_16x16x32_bf16 v[152:155], v[160:163], v[104:107], v[152:155]
    ds_read_b64_tr_b16 v[94:95], v18 offset:5120
    v_mfma_f32_16x16x32_bf16 v[156:159], v[160:163], v[112:115], v[156:159]
    buffer_load_dwordx4 v10, s[8:11], s44 offen offset:1024 lds
    v_mfma_f32_32x32x16_bf16 v[24:39], v[108:111], v[140:143], v[24:39]
    s_add_u32 m0, s42, 16384
    ds_read_b128 v[132:135], v15 offset:36864
    ds_read_b64_tr_b16 v[100:101], v19 offset:4096
    ds_read_b64_tr_b16 v[102:103], v19 offset:5120
    v_mfma_f32_32x32x16_bf16 v[40:55], v[108:111], v[148:151], v[40:55]
    buffer_load_dwordx4 v5, s[4:7], s43 offen lds
    s_add_u32 s44, s44, 114688
    s_cmp_ge_u32 s44, 1605632
    v_mfma_f32_32x32x16_bf16 v[56:71], v[116:119], v[140:143], v[56:71]
    s_cselect_b32 s44, s41, s44
    v_mfma_f32_32x32x16_bf16 v[72:87], v[116:119], v[148:151], v[72:87]
    buffer_load_dwordx4 v6, s[4:7], s43 offen offset:1024 lds
    v_mfma_f32_16x16x32_bf16 v[152:155], v[160:163], v[108:111], v[152:155]
    v_mfma_f32_16x16x32_bf16 v[156:159], v[160:163], v[116:119], v[156:159]
    s_waitcnt lgkmcnt(0)
    v_mfma_f32_32x32x16_bf16 v[24:39], v[88:91], v[120:123], v[24:39]
    s_waitcnt vmcnt(10)
    s_barrier
    v_mfma_f32_32x32x16_bf16 v[40:55], v[88:91], v[128:131], v[40:55]
    ds_read_b128 v[136:139], v16 offset:32768
    ds_read_b64_tr_b16 v[104:105], v18 offset:8192
    ds_read_b64_tr_b16 v[106:107], v18 offset:9216
    s_mov_b32 m0, s57
    v_mfma_f32_32x32x16_bf16 v[56:71], v[96:99], v[120:123], v[56:71]
    buffer_load_dwordx4 v9, s[8:11], s44 offen lds
    ds_read_b128 v[144:147], v16 offset:36864
    ds_read_b64_tr_b16 v[112:113], v19 offset:8192
    v_mfma_f32_32x32x16_bf16 v[72:87], v[96:99], v[128:131], v[72:87]
    ds_read_b64_tr_b16 v[114:115], v19 offset:9216
    ds_read_b128 v[140:143], v17 offset:32768
    ds_read_b64_tr_b16 v[108:109], v18 offset:12288
    v_mfma_f32_16x16x32_bf16 v[152:155], v[160:163], v[88:91], v[152:155]
    ds_read_b64_tr_b16 v[110:111], v18 offset:13312
    v_mfma_f32_16x16x32_bf16 v[156:159], v[160:163], v[96:99], v[156:159]
    buffer_load_dwordx4 v10, s[8:11], s44 offen offset:1024 lds
    v_mfma_f32_32x32x16_bf16 v[24:39], v[92:95], v[124:127], v[24:39]
    s_add_u32 m0, s42, 16384
    ds_read_b128 v[148:151], v17 offset:36864
    ds_read_b64_tr_b16 v[116:117], v19 offset:12288
    ds_read_b64_tr_b16 v[118:119], v19 offset:13312
    v_mfma_f32_32x32x16_bf16 v[40:55], v[92:95], v[132:135], v[40:55]
    buffer_load_dwordx4 v7, s[4:7], s43 offen offset:2048 lds
    s_add_u32 s44, s44, 114688
    s_cmp_ge_u32 s44, 1605632
    v_mfma_f32_32x32x16_bf16 v[56:71], v[100:103], v[124:127], v[56:71]
    s_cselect_b32 s44, s41, s44
    v_mfma_f32_32x32x16_bf16 v[72:87], v[100:103], v[132:135], v[72:87]
    buffer_load_dwordx4 v8, s[4:7], s43 offen offset:3072 lds
    v_mfma_f32_16x16x32_bf16 v[152:155], v[160:163], v[92:95], v[152:155]
    s_add_u32 s43, s43, 128
    s_cmp_eq_u32 s43, s63
    v_mfma_f32_16x16x32_bf16 v[156:159], v[160:163], v[100:103], v[156:159]
    s_cselect_b32 s43, s40, s43
    s_waitcnt lgkmcnt(0)
    v_mfma_f32_32x32x16_bf16 v[24:39], v[104:107], v[136:139], v[24:39]
    s_waitcnt vmcnt(8)
    s_barrier
    v_mfma_f32_32x32x16_bf16 v[40:55], v[104:107], v[144:147], v[40:55]
    ds_read_b128 v[120:123], v14 offset:0
    ds_read_b64_tr_b16 v[88:89], v18 offset:16384
    ds_read_b64_tr_b16 v[90:91], v18 offset:17408
    s_add_u32 m0, s57, 8192
    v_mfma_f32_32x32x16_bf16 v[56:71], v[112:115], v[136:139], v[56:71]
    buffer_load_dwordx4 v9, s[8:11], s44 offen lds
    ds_read_b128 v[128:131], v14 offset:4096
    ds_read_b64_tr_b16 v[96:97], v19 offset:16384
    v_mfma_f32_32x32x16_bf16 v[72:87], v[112:115], v[144:147], v[72:87]
    ds_read_b64_tr_b16 v[98:99], v19 offset:17408
    ds_read_b128 v[124:127], v15 offset:0
    ds_read_b64_tr_b16 v[92:93], v18 offset:20480
    v_mfma_f32_16x16x32_bf16 v[152:155], v[160:163], v[104:107], v[152:155]
    ds_read_b64_tr_b16 v[94:95], v18 offset:21504
    v_mfma_f32_16x16x32_bf16 v[156:159], v[160:163], v[112:115], v[156:159]
    buffer_load_dwordx4 v10, s[8:11], s44 offen offset:1024 lds
    v_mfma_f32_32x32x16_bf16 v[24:39], v[108:111], v[140:143], v[24:39]
    s_add_u32 m0, s42, 32768
    ds_read_b128 v[132:135], v15 offset:4096
    ds_read_b64_tr_b16 v[100:101], v19 offset:20480
    ds_read_b64_tr_b16 v[102:103], v19 offset:21504
    v_mfma_f32_32x32x16_bf16 v[40:55], v[108:111], v[148:151], v[40:55]
    buffer_load_dwordx4 v5, s[4:7], s43 offen lds
    s_add_u32 s44, s44, 114688
    s_cmp_ge_u32 s44, 1605632
    v_mfma_f32_32x32x16_bf16 v[56:71], v[116:119], v[140:143], v[56:71]
    s_cselect_b32 s44, s41, s44
    v_mfma_f32_32x32x16_bf16 v[72:87], v[116:119], v[148:151], v[72:87]
    buffer_load_dwordx4 v6, s[4:7], s43 offen offset:1024 lds
    v_mfma_f32_16x16x32_bf16 v[152:155], v[160:163], v[108:111], v[152:155]
    v_mfma_f32_16x16x32_bf16 v[156:159], v[160:163], v[116:119], v[156:159]
    s_waitcnt lgkmcnt(0)
    v_mfma_f32_32x32x16_bf16 v[24:39], v[88:91], v[120:123], v[24:39]
    s_waitcnt vmcnt(10)
    s_barrier
    v_mfma_f32_32x32x16_bf16 v[40:55], v[88:91], v[128:131], v[40:55]
    ds_read_b128 v[136:139], v16 offset:0
    ds_read_b64_tr_b16 v[104:105], v18 offset:24576
    ds_read_b64_tr_b16 v[106:107], v18 offset:25600
    s_add_u32 m0, s57, 16384
    v_mfma_f32_32x32x16_bf16 v[56:71], v[96:99], v[120:123], v[56:71]
    buffer_load_dwordx4 v9, s[8:11], s44 offen lds
    ds_read_b128 v[144:147], v16 offset:4096
    ds_read_b64_tr_b16 v[112:113], v19 offset:24576
    v_mfma_f32_32x32x16_bf16 v[72:87], v[96:99], v[128:131], v[72:87]
    ds_read_b64_tr_b16 v[114:115], v19 offset:25600
    ds_read_b128 v[140:143], v17 offset:0
    ds_read_b64_tr_b16 v[108:109], v18 offset:28672
    v_mfma_f32_16x16x32_bf16 v[152:155], v[160:163], v[88:91], v[152:155]
    ds_read_b64_tr_b16 v[110:111], v18 offset:29696
    v_mfma_f32_16x16x32_bf16 v[156:159], v[160:163], v[96:99], v[156:159]
    buffer_load_dwordx4 v10, s[8:11], s44 offen offset:1024 lds
    v_mfma_f32_32x32x16_bf16 v[24:39], v[92:95], v[124:127], v[24:39]
    s_add_u32 m0, s42, 32768
    ds_read_b128 v[148:151], v17 offset:4096
    ds_read_b64_tr_b16 v[116:117], v19 offset:28672
    ds_read_b64_tr_b16 v[118:119], v19 offset:29696
    v_mfma_f32_32x32x16_bf16 v[40:55], v[92:95], v[132:135], v[40:55]
    buffer_load_dwordx4 v7, s[4:7], s43 offen offset:2048 lds
    s_add_u32 s44, s44, 114688
    s_cmp_ge_u32 s44, 1605632
    v_mfma_f32_32x32x16_bf16 v[56:71], v[100:103], v[124:127], v[56:71]
    s_cselect_b32 s44, s41, s44
    v_mfma_f32_32x32x16_bf16 v[72:87], v[100:103], v[132:135], v[72:87]
    buffer_load_dwordx4 v8, s[4:7], s43 offen offset:3072 lds
    v_mfma_f32_16x16x32_bf16 v[152:155], v[160:163], v[92:95], v[152:155]
    s_add_u32 s43, s43, 128
    s_cmp_eq_u32 s43, s63
    v_mfma_f32_16x16x32_bf16 v[156:159], v[160:163], v[100:103], v[156:159]
    s_cselect_b32 s43, s40, s43
    s_waitcnt lgkmcnt(0)
    v_mfma_f32_32x32x16_bf16 v[24:39], v[104:107], v[136:139], v[24:39]
    s_waitcnt vmcnt(8)
    s_barrier
    v_mfma_f32_32x32x16_bf16 v[40:55], v[104:107], v[144:147], v[40:55]
    ds_read_b128 v[120:123], v14 offset:16384
    ds_read_b64_tr_b16 v[88:89], v18 offset:0
    ds_read_b64_tr_b16 v[90:91], v18 offset:1024
    s_add_u32 m0, s57, 24576
    v_mfma_f32_32x32x16_bf16 v[56:71], v[112:115], v[136:139], v[56:71]
    buffer_load_dwordx4 v9, s[8:11], s44 offen lds
    ds_read_b128 v[128:131], v14 offset:20480
    ds_read_b64_tr_b16 v[96:97], v19 offset:0
    v_mfma_f32_32x32x16_bf16 v[72:87], v[112:115], v[144:147], v[72:87]
    ds_read_b64_tr_b16 v[98:99], v19 offset:1024
    ds_read_b128 v[124:127], v15 offset:16384
    ds_read_b64_tr_b16 v[92:93], v18 offset:4096
    v_mfma_f32_16x16x32_bf16 v[152:155], v[160:163], v[104:107], v[152:155]
    ds_read_b64_tr_b16 v[94:95], v18 offset:5120
    v_mfma_f32_16x16x32_bf16 v[156:159], v[160:163], v[112:115], v[156:159]
    buffer_load_dwordx4 v10, s[8:11], s44 offen offset:1024 lds
    v_mfma_f32_32x32x16_bf16 v[24:39], v[108:111], v[140:143], v[24:39]
    s_mov_b32 m0, s42
    ds_read_b128 v[132:135], v15 offset:20480
    ds_read_b64_tr_b16 v[100:101], v19 offset:4096
    ds_read_b64_tr_b16 v[102:103], v19 offset:5120
    v_mfma_f32_32x32x16_bf16 v[40:55], v[108:111], v[148:151], v[40:55]
    buffer_load_dwordx4 v5, s[4:7], s43 offen lds
    s_add_u32 s44, s44, 114688
    s_cmp_ge_u32 s44, 1605632
    v_mfma_f32_32x32x16_bf16 v[56:71], v[116:119], v[140:143], v[56:71]
    s_cselect_b32 s44, s41, s44
    v_mfma_f32_32x32x16_bf16 v[72:87], v[116:119], v[148:151], v[72:87]
    buffer_load_dwordx4 v6, s[4:7], s43 offen offset:1024 lds
    v_mfma_f32_16x16x32_bf16 v[152:155], v[160:163], v[108:111], v[152:155]
    v_mfma_f32_16x16x32_bf16 v[156:159], v[160:163], v[116:119], v[156:159]
    s_waitcnt lgkmcnt(0)
    v_mfma_f32_32x32x16_bf16 v[24:39], v[88:91], v[120:123], v[24:39]
    s_waitcnt vmcnt(10)
    s_barrier
    v_mfma_f32_32x32x16_bf16 v[40:55], v[88:91], v[128:131], v[40:55]
    ds_read_b128 v[136:139], v16 offset:16384
    ds_read_b64_tr_b16 v[104:105], v18 offset:8192
    ds_read_b64_tr_b16 v[106:107], v18 offset:9216
    s_mov_b32 m0, s57
    v_mfma_f32_32x32x16_bf16 v[56:71], v[96:99], v[120:123], v[56:71]
    buffer_load_dwordx4 v9, s[8:11], s44 offen lds
    ds_read_b128 v[144:147], v16 offset:20480
    ds_read_b64_tr_b16 v[112:113], v19 offset:8192
    v_mfma_f32_32x32x16_bf16 v[72:87], v[96:99], v[128:131], v[72:87]
    ds_read_b64_tr_b16 v[114:115], v19 offset:9216
    ds_read_b128 v[140:143], v17 offset:16384
    ds_read_b64_tr_b16 v[108:109], v18 offset:12288
    v_mfma_f32_16x16x32_bf16 v[152:155], v[160:163], v[88:91], v[152:155]
    ds_read_b64_tr_b16 v[110:111], v18 offset:13312
    v_mfma_f32_16x16x32_bf16 v[156:159], v[160:163], v[96:99], v[156:159]
    buffer_load_dwordx4 v10, s[8:11], s44 offen offset:1024 lds
    v_mfma_f32_32x32x16_bf16 v[24:39], v[92:95], v[124:127], v[24:39]
    s_mov_b32 m0, s42
    ds_read_b128 v[148:151], v17 offset:20480
    ds_read_b64_tr_b16 v[116:117], v19 offset:12288
    ds_read_b64_tr_b16 v[118:119], v19 offset:13312
    v_mfma_f32_32x32x16_bf16 v[40:55], v[92:95], v[132:135], v[40:55]
    buffer_load_dwordx4 v7, s[4:7], s43 offen offset:2048 lds
    s_add_u32 s44, s44, 114688
    s_cmp_ge_u32 s44, 1605632
    v_mfma_f32_32x32x16_bf16 v[56:71], v[100:103], v[124:127], v[56:71]
    s_cselect_b32 s44, s41, s44
    v_mfma_f32_32x32x16_bf16 v[72:87], v[100:103], v[132:135], v[72:87]
    buffer_load_dwordx4 v8, s[4:7], s43 offen offset:3072 lds
    v_mfma_f32_16x16x32_bf16 v[152:155], v[160:163], v[92:95], v[152:155]
    s_add_u32 s43, s43, 128
    s_cmp_eq_u32 s43, s63
    v_mfma_f32_16x16x32_bf16 v[156:159], v[160:163], v[100:103], v[156:159]
    s_cselect_b32 s43, s40, s43
    s_waitcnt lgkmcnt(0)
    v_mfma_f32_32x32x16_bf16 v[24:39], v[104:107], v[136:139], v[24:39]
    s_waitcnt vmcnt(8)
    s_barrier
    v_mfma_f32_32x32x16_bf16 v[40:55], v[104:107], v[144:147], v[40:55]
    ds_read_b128 v[120:123], v14 offset:32768
    ds_read_b64_tr_b16 v[88:89], v18 offset:16384
    ds_read_b64_tr_b16 v[90:91], v18 offset:17408
    s_add_u32 m0, s57, 8192
    v_mfma_f32_32x32x16_bf16 v[56:71], v[112:115], v[136:139], v[56:71]
    buffer_load_dwordx4 v9, s[8:11], s44 offen lds
    ds_read_b128 v[128:131], v14 offset:36864
    ds_read_b64_tr_b16 v[96:97], v19 offset:16384
    v_mfma_f32_32x32x16_bf16 v[72:87], v[112:115], v[144:147], v[72:87]
    ds_read_b64_tr_b16 v[98:99], v19 offset:17408
    ds_read_b128 v[124:127], v15 offset:32768
    ds_read_b64_tr_b16 v[92:93], v18 offset:20480
    v_mfma_f32_16x16x32_bf16 v[152:155], v[160:163], v[104:107], v[152:155]
    ds_read_b64_tr_b16 v[94:95], v18 offset:21504
    v_mfma_f32_16x16x32_bf16 v[156:159], v[160:163], v[112:115], v[156:159]
    buffer_load_dwordx4 v10, s[8:11], s44 offen offset:1024 lds
    v_mfma_f32_32x32x16_bf16 v[24:39], v[108:111], v[140:143], v[24:39]
    ds_read_b128 v[132:135], v15 offset:36864
    ds_read_b64_tr_b16 v[100:101], v19 offset:20480
    ds_read_b64_tr_b16 v[102:103], v19 offset:21504
    v_mfma_f32_32x32x16_bf16 v[40:55], v[108:111], v[148:151], v[40:55]
    s_add_u32 s44, s44, 114688
    s_cmp_ge_u32 s44, 1605632
    v_mfma_f32_32x32x16_bf16 v[56:71], v[116:119], v[140:143], v[56:71]
    s_cselect_b32 s44, s41, s44
    v_mfma_f32_32x32x16_bf16 v[72:87], v[116:119], v[148:151], v[72:87]
    v_mfma_f32_16x16x32_bf16 v[152:155], v[160:163], v[108:111], v[152:155]
    v_mfma_f32_16x16x32_bf16 v[156:159], v[160:163], v[116:119], v[156:159]
    s_lshl_b32 s45, s33, 12
    s_lshl_b32 s46, s51, 11
    s_add_u32 s45, s45, s46
    s_add_u32 s45, s45, 1900544
    buffer_load_dwordx4 v[164:167], v180, s[12:15], s45 offen offset:0 sc1
    buffer_load_dwordx4 v[168:171], v180, s[12:15], s45 offen offset:16 sc1
    buffer_load_dwordx4 v[172:175], v180, s[12:15], s45 offen offset:1024 sc1
    buffer_load_dwordx4 v[176:179], v180, s[12:15], s45 offen offset:1040 sc1
    buffer_load_dword v181, v182, s[52:55], 0 offen sc1
    v_mul_u32_u24 v252, 896, v1
    s_mul_i32 s45, s32, 448
    s_mul_i32 s46, s36, 112
    s_add_u32 s45, s45, s46
    s_mul_i32 s45, s45, 896
    s_lshl_b32 s46, s37, 7
    s_add_u32 s45, s45, s46
    buffer_load_dword v253, v252, s[20:23], s45 offen
    s_mul_i32 s45, s32, 448
    s_mul_i32 s46, s36, 112
    s_add_u32 s45, s45, s46
    s_add_u32 s45, s45, 64
    s_mul_i32 s45, s45, 896
    s_lshl_b32 s46, s37, 7
    s_add_u32 s45, s45, s46
    s_mov_b32 exec_hi, 0xffff
    buffer_load_dword v253, v252, s[20:23], s45 offen
    s_mov_b64 exec, -1
    s_lshl_b32 s61, s35, 2
    s_add_u32 s61, s61, s36
    v_lshrrev_b32 v2, 3, v1
    v_mul_u32_u24 v250, 896, v2
    v_and_b32 v3, 7, v1
    v_bfe_u32 v4, v1, 4, 1
    v_lshlrev_b32 v4, 2, v4
    v_xor_b32 v3, v3, v4
    v_lshl_add_u32 v250, v3, 4, v250
    s_mul_i32 s38, s32, 401408
    s_lshl_b32 s45, s37, 7
    s_add_u32 s38, s38, s45
    s_lshl_b32 s39, s32, 11
    v_add_u32 v251, 6144, v250
    s_lshl_b32 s45, s36, 1
    s_add_u32 s45, s45, s37
    s_cmp_ge_u32 s45, 7
    s_cselect_b32 s42, 7, 0
    s_sub_u32 s42, s45, s42
    s_mul_i32 s40, s42, 57344
    s_add_u32 s40, s40, s38
    s_add_u32 s41, s38, 401408
    s_lshl_b32 s42, s42, 12
    s_waitcnt lgkmcnt(0)
    v_mfma_f32_32x32x16_bf16 v[24:39], v[88:91], v[120:123], v[24:39]
    s_waitcnt vmcnt(15)
    s_barrier
    v_mfma_f32_32x32x16_bf16 v[40:55], v[88:91], v[128:131], v[40:55]
    ds_read_b128 v[136:139], v16 offset:32768
    ds_read_b64_tr_b16 v[104:105], v18 offset:24576
    ds_read_b64_tr_b16 v[106:107], v18 offset:25600
    v_mfma_f32_32x32x16_bf16 v[56:71], v[96:99], v[120:123], v[56:71]
    ds_read_b128 v[144:147], v16 offset:36864
    ds_read_b64_tr_b16 v[112:113], v19 offset:24576
    v_mfma_f32_32x32x16_bf16 v[72:87], v[96:99], v[128:131], v[72:87]
    ds_read_b64_tr_b16 v[114:115], v19 offset:25600
    ds_read_b128 v[140:143], v17 offset:32768
    ds_read_b64_tr_b16 v[108:109], v18 offset:28672
    v_mfma_f32_16x16x32_bf16 v[152:155], v[160:163], v[88:91], v[152:155]
    ds_read_b64_tr_b16 v[110:111], v18 offset:29696
    v_mfma_f32_16x16x32_bf16 v[156:159], v[160:163], v[96:99], v[156:159]
    v_mfma_f32_32x32x16_bf16 v[24:39], v[92:95], v[124:127], v[24:39]
    ds_read_b128 v[148:151], v17 offset:36864
    ds_read_b64_tr_b16 v[116:117], v19 offset:28672
    ds_read_b64_tr_b16 v[118:119], v19 offset:29696
    v_mfma_f32_32x32x16_bf16 v[40:55], v[92:95], v[132:135], v[40:55]
    v_mfma_f32_32x32x16_bf16 v[56:71], v[100:103], v[124:127], v[56:71]
    v_mfma_f32_32x32x16_bf16 v[72:87], v[100:103], v[132:135], v[72:87]
    v_mfma_f32_16x16x32_bf16 v[152:155], v[160:163], v[92:95], v[152:155]
    v_mfma_f32_16x16x32_bf16 v[156:159], v[160:163], v[100:103], v[156:159]
    s_waitcnt lgkmcnt(0)
    v_mfma_f32_32x32x16_bf16 v[24:39], v[104:107], v[136:139], v[24:39]
    s_waitcnt vmcnt(9)
    s_barrier
    v_mfma_f32_32x32x16_bf16 v[40:55], v[104:107], v[144:147], v[40:55]
    ds_read_b128 v[120:123], v14 offset:0
    ds_read_b64_tr_b16 v[88:89], v18 offset:0
    ds_read_b64_tr_b16 v[90:91], v18 offset:1024
    v_mfma_f32_32x32x16_bf16 v[56:71], v[112:115], v[136:139], v[56:71]
    ds_read_b128 v[128:131], v14 offset:4096
    ds_read_b64_tr_b16 v[96:97], v19 offset:0
    v_mfma_f32_32x32x16_bf16 v[72:87], v[112:115], v[144:147], v[72:87]
    ds_read_b64_tr_b16 v[98:99], v19 offset:1024
    ds_read_b128 v[124:127], v15 offset:0
    ds_read_b64_tr_b16 v[92:93], v18 offset:4096
    v_mfma_f32_16x16x32_bf16 v[152:155], v[160:163], v[104:107], v[152:155]
    ds_read_b64_tr_b16 v[94:95], v18 offset:5120
    v_mfma_f32_16x16x32_bf16 v[156:159], v[160:163], v[112:115], v[156:159]
    v_mfma_f32_32x32x16_bf16 v[24:39], v[108:111], v[140:143], v[24:39]
    ds_read_b128 v[132:135], v15 offset:4096
    ds_read_b64_tr_b16 v[100:101], v19 offset:4096
    ds_read_b64_tr_b16 v[102:103], v19 offset:5120
    v_mfma_f32_32x32x16_bf16 v[40:55], v[108:111], v[148:151], v[40:55]
    v_mfma_f32_32x32x16_bf16 v[56:71], v[116:119], v[140:143], v[56:71]
    v_mfma_f32_32x32x16_bf16 v[72:87], v[116:119], v[148:151], v[72:87]
    v_mfma_f32_16x16x32_bf16 v[152:155], v[160:163], v[108:111], v[152:155]
    v_mfma_f32_16x16x32_bf16 v[156:159], v[160:163], v[116:119], v[156:159]
    s_waitcnt lgkmcnt(0)
    v_mfma_f32_32x32x16_bf16 v[24:39], v[88:91], v[120:123], v[24:39]
    s_waitcnt vmcnt(7)
    s_barrier
    v_mfma_f32_32x32x16_bf16 v[40:55], v[88:91], v[128:131], v[40:55]
    ds_read_b128 v[136:139], v16 offset:0
    ds_read_b64_tr_b16 v[104:105], v18 offset:8192
    ds_read_b64_tr_b16 v[106:107], v18 offset:9216
    v_mfma_f32_32x32x16_bf16 v[56:71], v[96:99], v[120:123], v[56:71]
    ds_read_b128 v[144:147], v16 offset:4096
    ds_read_b64_tr_b16 v[112:113], v19 offset:8192
    v_mfma_f32_32x32x16_bf16 v[72:87], v[96:99], v[128:131], v[72:87]
    ds_read_b64_tr_b16 v[114:115], v19 offset:9216
    ds_read_b128 v[140:143], v17 offset:0
    ds_read_b64_tr_b16 v[108:109], v18 offset:12288
    v_mfma_f32_16x16x32_bf16 v[152:155], v[160:163], v[88:91], v[152:155]
    ds_read_b64_tr_b16 v[110:111], v18 offset:13312
    v_mfma_f32_16x16x32_bf16 v[156:159], v[160:163], v[96:99], v[156:159]
    v_mfma_f32_32x32x16_bf16 v[24:39], v[92:95], v[124:127], v[24:39]
    ds_read_b128 v[148:151], v17 offset:4096
    ds_read_b64_tr_b16 v[116:117], v19 offset:12288
    ds_read_b64_tr_b16 v[118:119], v19 offset:13312
    v_mfma_f32_32x32x16_bf16 v[40:55], v[92:95], v[132:135], v[40:55]
    v_mfma_f32_32x32x16_bf16 v[56:71], v[100:103], v[124:127], v[56:71]
    v_mfma_f32_32x32x16_bf16 v[72:87], v[100:103], v[132:135], v[72:87]
    v_mfma_f32_16x16x32_bf16 v[152:155], v[160:163], v[92:95], v[152:155]
    v_mfma_f32_16x16x32_bf16 v[156:159], v[160:163], v[100:103], v[156:159]
    s_waitcnt lgkmcnt(0)
    s_barrier
    s_add_u32 m0, s39, 16384
    s_nop 0
    buffer_load_dwordx4 v250, s[20:23], s40 offen lds
    buffer_load_dwordx4 v251, s[20:23], s40 offen offset:1024 lds
    s_add_u32 s40, s40, 14336
    s_cmp_eq_u32 s40, s41
    s_cselect_b32 s40, s38, s40
    s_add_u32 m0, s39, 24576
    s_nop 0
    buffer_load_dwordx4 v250, s[20:23], s40 offen lds
    buffer_load_dwordx4 v251, s[20:23], s40 offen offset:1024 lds
    s_add_u32 s40, s40, 14336
    s_cmp_eq_u32 s40, s41
    s_cselect_b32 s40, s38, s40
    s_add_u32 m0, s39, 65536
    s_nop 0
    buffer_load_dwordx4 v250, s[20:23], s40 offen lds
    buffer_load_dwordx4 v251, s[20:23], s40 offen offset:1024 lds
    s_add_u32 s40, s40, 14336
    s_cmp_eq_u32 s40, s41
    s_cselect_b32 s40, s38, s40
    s_add_u32 m0, s39, 32768
    s_nop 0
    buffer_load_dwordx4 v250, s[20:23], s40 offen lds
    buffer_load_dwordx4 v251, s[20:23], s40 offen offset:1024 lds
    s_add_u32 s40, s40, 14336
    s_cmp_eq_u32 s40, s41
    s_cselect_b32 s40, s38, s40
    v_mfma_f32_16x16x32_bf16 v[152:155], v[160:163], v[104:107], v[152:155]
    v_mfma_f32_16x16x32_bf16 v[156:159], v[160:163], v[112:115], v[156:159]
    v_mfma_f32_16x16x32_bf16 v[152:155], v[160:163], v[108:111], v[152:155]
    v_mfma_f32_16x16x32_bf16 v[156:159], v[160:163], v[116:119], v[156:159]
    v_mfma_f32_32x32x16_bf16 v[24:39], v[104:107], v[136:139], v[24:39]
    v_mfma_f32_32x32x16_bf16 v[40:55], v[104:107], v[144:147], v[40:55]
    v_mfma_f32_32x32x16_bf16 v[56:71], v[112:115], v[136:139], v[56:71]
    v_mfma_f32_32x32x16_bf16 v[72:87], v[112:115], v[144:147], v[72:87]
    v_mfma_f32_32x32x16_bf16 v[24:39], v[108:111], v[140:143], v[24:39]
    v_mfma_f32_32x32x16_bf16 v[40:55], v[108:111], v[148:151], v[40:55]
    v_mfma_f32_32x32x16_bf16 v[56:71], v[116:119], v[140:143], v[56:71]
    v_mfma_f32_32x32x16_bf16 v[72:87], v[116:119], v[148:151], v[72:87]
    s_mov_b32 s48, -1
    s_mov_b32 s49, 0
    s_waitcnt vmcnt(10)
    s_mov_b32 s59, 4000
G1_CK_15:
    s_lshl_b32 s45, s33, 2
    s_lshl_b32 s46, s51, 1
    s_add_u32 s45, s45, s46
    s_add_u32 s46, s45, 1
    v_readlane_b32 s56, v181, 0
    v_readlane_b32 s57, v181, s45
    v_readlane_b32 s58, v181, s46
    s_nop 0
    v_xor_b32 v120, s57, v167
    v_xor_b32 v121, s57, v171
    v_or_b32 v120, v120, v121
    v_xor_b32 v121, s58, v175
    v_or_b32 v120, v120, v121
    v_xor_b32 v121, s58, v179
    v_or_b32 v120, v120, v121
    v_cmp_ne_u32 vcc, 0, v120
    s_and_b32 s45, s57, s58
    s_and_b32 s45, s45, s56
    s_and_b32 s45, s45, 1
    s_xor_b32 s45, s45, 1
    s_or_b32 s45, s45, vcc_lo
    s_or_b32 s45, s45, vcc_hi
    s_cmp_eq_u32 s45, 0
    s_cbranch_scc1 G1_OK_16
    s_sub_u32 s59, s59, 1
    s_cbranch_scc1 G1_OK_16
    s_lshl_b32 s45, s33, 12
    s_lshl_b32 s46, s51, 11
    s_add_u32 s45, s45, s46
    s_add_u32 s45, s45, 1900544
    buffer_load_dwordx4 v[164:167], v180, s[12:15], s45 offen offset:0 sc1
    buffer_load_dwordx4 v[168:171], v180, s[12:15], s45 offen offset:16 sc1
    buffer_load_dwordx4 v[172:175], v180, s[12:15], s45 offen offset:1024 sc1
    buffer_load_dwordx4 v[176:179], v180, s[12:15], s45 offen offset:1040 sc1
    buffer_load_dword v181, v182, s[52:55], 0 offen sc1
    s_waitcnt vmcnt(0)
    s_branch G1_CK_15
G1_OK_16:
    v_mov_b32 v167, 0
    v_mov_b32 v175, 0
    v_permlane16_swap_b32 v152, v153
    v_cvt_pk_bf16_f32 v88, v152, v152
    v_and_b32 v121, 0xffff0000, v88
    v_sub_f32 v121, v152, v121
    v_and_b32 v89, 0xffff, v88
    v_cvt_pk_bf16_f32 v88, v152, v121
    v_lshl_or_b32 v89, v12, 16, v89
    v_mov_b32 v90, v12
    v_mov_b32 v91, 0
    v_cndmask_b32 v88, 0, v88, s[48:49]
    v_cndmask_b32 v89, 0, v89, s[48:49]
    v_cndmask_b32 v90, 0, v90, s[48:49]
    v_permlane16_swap_b32 v156, v157
    v_cvt_pk_bf16_f32 v92, v156, v156
    v_and_b32 v121, 0xffff0000, v92
    v_sub_f32 v121, v156, v121
    v_and_b32 v93, 0xffff, v92
    v_cvt_pk_bf16_f32 v92, v156, v121
    v_lshl_or_b32 v93, v13, 16, v93
    v_mov_b32 v94, v13
    v_mov_b32 v95, 0
    v_cndmask_b32 v92, 0, v92, s[48:49]
    v_cndmask_b32 v93, 0, v93, s[48:49]
    v_cndmask_b32 v94, 0, v94, s[48:49]
    v_mfma_f32_32x32x16_bf16 v[24:39], v[88:91], v[164:167], v[24:39]
    v_mfma_f32_32x32x16_bf16 v[40:55], v[88:91], v[172:175], v[40:55]
    v_mfma_f32_32x32x16_bf16 v[56:71], v[92:95], v[164:167], v[56:71]
    v_mfma_f32_32x32x16_bf16 v[72:87], v[92:95], v[172:175], v[72:87]
    v_lshlrev_b32 v183, 4, v1
    s_lshl_b32 s45, s33, 2
    s_lshl_b32 s46, s51, 1
    s_add_u32 s45, s45, s46
    s_mul_i32 s45, s45, 112
    s_lshl_b32 s46, s34, 3
    s_add_u32 s45, s45, s46
    s_lshl_b32 s46, s50, 2
    s_add_u32 s45, s45, s46
    s_lshl_b32 s45, s45, 10
    s_add_u32 s45, s45, 6291456
    s_add_u32 s46, s45, 114688
    v_mov_b32 v166, v169
    v_pk_mul_f32 v[104:105], v[24:25], v[24:25]
    v_pk_mul_f32 v[106:107], v[26:27], v[26:27]
    v_pk_mul_f32 v[108:109], v[28:29], v[28:29]
    v_pk_mul_f32 v[110:111], v[30:31], v[30:31]
    v_pk_fma_f32 v[104:105], v[104:105], v[166:167], v[168:169] op_sel_hi:[1,0,0]
    v_pk_fma_f32 v[106:107], v[106:107], v[166:167], v[168:169] op_sel_hi:[1,0,0]
    v_pk_fma_f32 v[108:109], v[108:109], v[166:167], v[168:169] op_sel_hi:[1,0,0]
    v_pk_fma_f32 v[110:111], v[110:111], v[166:167], v[168:169] op_sel_hi:[1,0,0]
    v_pk_mul_f32 v[104:105], v[104:105], v[24:25]
    v_pk_mul_f32 v[106:107], v[106:107], v[26:27]
    v_pk_mul_f32 v[108:109], v[108:109], v[28:29]
    v_pk_mul_f32 v[110:111], v[110:111], v[30:31]
    v_exp_f32 v104, v104
    v_exp_f32 v105, v105
    v_exp_f32 v106, v106
    v_exp_f32 v107, v107
    v_exp_f32 v108, v108
    v_exp_f32 v109, v109
    v_exp_f32 v110, v110
    v_exp_f32 v111, v111
    v_pk_fma_f32 v[104:105], v[104:105], v[170:171], v[170:171] op_sel:[0,0,0] op_sel_hi:[1,0,0]
    v_pk_fma_f32 v[106:107], v[106:107], v[170:171], v[170:171] op_sel:[0,0,0] op_sel_hi:[1,0,0]
    v_pk_fma_f32 v[108:109], v[108:109], v[170:171], v[170:171] op_sel:[0,0,0] op_sel_hi:[1,0,0]
    v_pk_fma_f32 v[110:111], v[110:111], v[170:171], v[170:171] op_sel:[0,0,0] op_sel_hi:[1,0,0]
    v_rcp_f32 v104, v104
    v_rcp_f32 v105, v105
    v_rcp_f32 v106, v106
    v_rcp_f32 v107, v107
    v_rcp_f32 v108, v108
    v_rcp_f32 v109, v109
    v_rcp_f32 v110, v110
    v_rcp_f32 v111, v111
    v_pk_mul_f32 v[104:105], v[104:105], v[24:25]
    v_pk_mul_f32 v[106:107], v[106:107], v[26:27]
    v_pk_mul_f32 v[108:109], v[108:109], v[28:29]
    v_pk_mul_f32 v[110:111], v[110:111], v[30:31]
    v_cvt_pk_bf16_f32 v120, v104, v105
    v_cvt_pk_bf16_f32 v121, v106, v107
    v_cvt_pk_bf16_f32 v122, v108, v109
    v_cvt_pk_bf16_f32 v123, v110, v111
    buffer_store_dwordx4 v[120:123], v183, s[12:15], s45 offen offset:0 sc1
    v_pk_mul_f32 v[136:137], v[32:33], v[32:33]
    v_pk_mul_f32 v[138:139], v[34:35], v[34:35]
    v_pk_mul_f32 v[140:141], v[36:37], v[36:37]
    v_pk_mul_f32 v[142:143], v[38:39], v[38:39]
    v_pk_fma_f32 v[136:137], v[136:137], v[166:167], v[168:169] op_sel_hi:[1,0,0]
    v_pk_fma_f32 v[138:139], v[138:139], v[166:167], v[168:169] op_sel_hi:[1,0,0]
    v_pk_fma_f32 v[140:141], v[140:141], v[166:167], v[168:169] op_sel_hi:[1,0,0]
    v_pk_fma_f32 v[142:143], v[142:143], v[166:167], v[168:169] op_sel_hi:[1,0,0]
    v_pk_mul_f32 v[136:137], v[136:137], v[32:33]
    v_pk_mul_f32 v[138:139], v[138:139], v[34:35]
    v_pk_mul_f32 v[140:141], v[140:141], v[36:37]
    v_pk_mul_f32 v[142:143], v[142:143], v[38:39]
    v_exp_f32 v136, v136
    v_exp_f32 v137, v137
    v_exp_f32 v138, v138
    v_exp_f32 v139, v139
    v_exp_f32 v140, v140
    v_exp_f32 v141, v141
    v_exp_f32 v142, v142
    v_exp_f32 v143, v143
    v_pk_fma_f32 v[136:137], v[136:137], v[170:171], v[170:171] op_sel:[0,0,0] op_sel_hi:[1,0,0]
    v_pk_fma_f32 v[138:139], v[138:139], v[170:171], v[170:171] op_sel:[0,0,0] op_sel_hi:[1,0,0]
    v_pk_fma_f32 v[140:141], v[140:141], v[170:171], v[170:171] op_sel:[0,0,0] op_sel_hi:[1,0,0]
    v_pk_fma_f32 v[142:143], v[142:143], v[170:171], v[170:171] op_sel:[0,0,0] op_sel_hi:[1,0,0]
    v_rcp_f32 v136, v136
    v_rcp_f32 v137, v137
    v_rcp_f32 v138, v138
    v_rcp_f32 v139, v139
    v_rcp_f32 v140, v140
    v_rcp_f32 v141, v141
    v_rcp_f32 v142, v142
    v_rcp_f32 v143, v143
    v_pk_mul_f32 v[136:137], v[136:137], v[32:33]
    v_pk_mul_f32 v[138:139], v[138:139], v[34:35]
    v_pk_mul_f32 v[140:141], v[140:141], v[36:37]
    v_pk_mul_f32 v[142:143], v[142:143], v[38:39]
    v_cvt_pk_bf16_f32 v128, v136, v137
    v_cvt_pk_bf16_f32 v129, v138, v139
    v_cvt_pk_bf16_f32 v130, v140, v141
    v_cvt_pk_bf16_f32 v131, v142, v143
    buffer_store_dwordx4 v[128:131], v183, s[12:15], s45 offen offset:1024 sc1
    v_pk_mul_f32 v[104:105], v[56:57], v[56:57]
    v_pk_mul_f32 v[106:107], v[58:59], v[58:59]
    v_pk_mul_f32 v[108:109], v[60:61], v[60:61]
    v_pk_mul_f32 v[110:111], v[62:63], v[62:63]
    v_pk_fma_f32 v[104:105], v[104:105], v[166:167], v[168:169] op_sel_hi:[1,0,0]
    v_pk_fma_f32 v[106:107], v[106:107], v[166:167], v[168:169] op_sel_hi:[1,0,0]
    v_pk_fma_f32 v[108:109], v[108:109], v[166:167], v[168:169] op_sel_hi:[1,0,0]
    v_pk_fma_f32 v[110:111], v[110:111], v[166:167], v[168:169] op_sel_hi:[1,0,0]
    v_pk_mul_f32 v[104:105], v[104:105], v[56:57]
    v_pk_mul_f32 v[106:107], v[106:107], v[58:59]
    v_pk_mul_f32 v[108:109], v[108:109], v[60:61]
    v_pk_mul_f32 v[110:111], v[110:111], v[62:63]
    v_exp_f32 v104, v104
    v_exp_f32 v105, v105
    v_exp_f32 v106, v106
    v_exp_f32 v107, v107
    v_exp_f32 v108, v108
    v_exp_f32 v109, v109
    v_exp_f32 v110, v110
    v_exp_f32 v111, v111
    v_pk_fma_f32 v[104:105], v[104:105], v[170:171], v[170:171] op_sel:[0,0,0] op_sel_hi:[1,0,0]
    v_pk_fma_f32 v[106:107], v[106:107], v[170:171], v[170:171] op_sel:[0,0,0] op_sel_hi:[1,0,0]
    v_pk_fma_f32 v[108:109], v[108:109], v[170:171], v[170:171] op_sel:[0,0,0] op_sel_hi:[1,0,0]
    v_pk_fma_f32 v[110:111], v[110:111], v[170:171], v[170:171] op_sel:[0,0,0] op_sel_hi:[1,0,0]
    v_rcp_f32 v104, v104
    v_rcp_f32 v105, v105
    v_rcp_f32 v106, v106
    v_rcp_f32 v107, v107
    v_rcp_f32 v108, v108
    v_rcp_f32 v109, v109
    v_rcp_f32 v110, v110
    v_rcp_f32 v111, v111
    v_pk_mul_f32 v[104:105], v[104:105], v[56:57]
    v_pk_mul_f32 v[106:107], v[106:107], v[58:59]
    v_pk_mul_f32 v[108:109], v[108:109], v[60:61]
    v_pk_mul_f32 v[110:111], v[110:111], v[62:63]
    v_cvt_pk_bf16_f32 v120, v104, v105
    v_cvt_pk_bf16_f32 v121, v106, v107
    v_cvt_pk_bf16_f32 v122, v108, v109
    v_cvt_pk_bf16_f32 v123, v110, v111
    buffer_store_dwordx4 v[120:123], v183, s[12:15], s45 offen offset:2048 sc1
    v_pk_mul_f32 v[136:137], v[64:65], v[64:65]
    v_pk_mul_f32 v[138:139], v[66:67], v[66:67]
    v_pk_mul_f32 v[140:141], v[68:69], v[68:69]
    v_pk_mul_f32 v[142:143], v[70:71], v[70:71]
    v_pk_fma_f32 v[136:137], v[136:137], v[166:167], v[168:169] op_sel_hi:[1,0,0]
    v_pk_fma_f32 v[138:139], v[138:139], v[166:167], v[168:169] op_sel_hi:[1,0,0]
    v_pk_fma_f32 v[140:141], v[140:141], v[166:167], v[168:169] op_sel_hi:[1,0,0]
    v_pk_fma_f32 v[142:143], v[142:143], v[166:167], v[168:169] op_sel_hi:[1,0,0]
    v_pk_mul_f32 v[136:137], v[136:137], v[64:65]
    v_pk_mul_f32 v[138:139], v[138:139], v[66:67]
    v_pk_mul_f32 v[140:141], v[140:141], v[68:69]
    v_pk_mul_f32 v[142:143], v[142:143], v[70:71]
    v_exp_f32 v136, v136
    v_exp_f32 v137, v137
    v_exp_f32 v138, v138
    v_exp_f32 v139, v139
    v_exp_f32 v140, v140
    v_exp_f32 v141, v141
    v_exp_f32 v142, v142
    v_exp_f32 v143, v143
    v_pk_fma_f32 v[136:137], v[136:137], v[170:171], v[170:171] op_sel:[0,0,0] op_sel_hi:[1,0,0]
    v_pk_fma_f32 v[138:139], v[138:139], v[170:171], v[170:171] op_sel:[0,0,0] op_sel_hi:[1,0,0]
    v_pk_fma_f32 v[140:141], v[140:141], v[170:171], v[170:171] op_sel:[0,0,0] op_sel_hi:[1,0,0]
    v_pk_fma_f32 v[142:143], v[142:143], v[170:171], v[170:171] op_sel:[0,0,0] op_sel_hi:[1,0,0]
    v_rcp_f32 v136, v136
    v_rcp_f32 v137, v137
    v_rcp_f32 v138, v138
    v_rcp_f32 v139, v139
    v_rcp_f32 v140, v140
    v_rcp_f32 v141, v141
    v_rcp_f32 v142, v142
    v_rcp_f32 v143, v143
    v_pk_mul_f32 v[136:137], v[136:137], v[64:65]
    v_pk_mul_f32 v[138:139], v[138:139], v[66:67]
    v_pk_mul_f32 v[140:141], v[140:141], v[68:69]
    v_pk_mul_f32 v[142:143], v[142:143], v[70:71]
    v_cvt_pk_bf16_f32 v128, v136, v137
    v_cvt_pk_bf16_f32 v129, v138, v139
    v_cvt_pk_bf16_f32 v130, v140, v141
    v_cvt_pk_bf16_f32 v131, v142, v143
    buffer_store_dwordx4 v[128:131], v183, s[12:15], s45 offen offset:3072 sc1
    v_mov_b32 v174, v177
    v_pk_mul_f32 v[104:105], v[40:41], v[40:41]
    v_pk_mul_f32 v[106:107], v[42:43], v[42:43]
    v_pk_mul_f32 v[108:109], v[44:45], v[44:45]
    v_pk_mul_f32 v[110:111], v[46:47], v[46:47]
    v_pk_fma_f32 v[104:105], v[104:105], v[174:175], v[176:177] op_sel_hi:[1,0,0]
    v_pk_fma_f32 v[106:107], v[106:107], v[174:175], v[176:177] op_sel_hi:[1,0,0]
    v_pk_fma_f32 v[108:109], v[108:109], v[174:175], v[176:177] op_sel_hi:[1,0,0]
    v_pk_fma_f32 v[110:111], v[110:111], v[174:175], v[176:177] op_sel_hi:[1,0,0]
    v_pk_mul_f32 v[104:105], v[104:105], v[40:41]
    v_pk_mul_f32 v[106:107], v[106:107], v[42:43]
    v_pk_mul_f32 v[108:109], v[108:109], v[44:45]
    v_pk_mul_f32 v[110:111], v[110:111], v[46:47]
    v_exp_f32 v104, v104
    v_exp_f32 v105, v105
    v_exp_f32 v106, v106
    v_exp_f32 v107, v107
    v_exp_f32 v108, v108
    v_exp_f32 v109, v109
    v_exp_f32 v110, v110
    v_exp_f32 v111, v111
    v_pk_fma_f32 v[104:105], v[104:105], v[178:179], v[178:179] op_sel:[0,0,0] op_sel_hi:[1,0,0]
    v_pk_fma_f32 v[106:107], v[106:107], v[178:179], v[178:179] op_sel:[0,0,0] op_sel_hi:[1,0,0]
    v_pk_fma_f32 v[108:109], v[108:109], v[178:179], v[178:179] op_sel:[0,0,0] op_sel_hi:[1,0,0]
    v_pk_fma_f32 v[110:111], v[110:111], v[178:179], v[178:179] op_sel:[0,0,0] op_sel_hi:[1,0,0]
    v_rcp_f32 v104, v104
    v_rcp_f32 v105, v105
    v_rcp_f32 v106, v106
    v_rcp_f32 v107, v107
    v_rcp_f32 v108, v108
    v_rcp_f32 v109, v109
    v_rcp_f32 v110, v110
    v_rcp_f32 v111, v111
    v_pk_mul_f32 v[104:105], v[104:105], v[40:41]
    v_pk_mul_f32 v[106:107], v[106:107], v[42:43]
    v_pk_mul_f32 v[108:109], v[108:109], v[44:45]
    v_pk_mul_f32 v[110:111], v[110:111], v[46:47]
    v_cvt_pk_bf16_f32 v120, v104, v105
    v_cvt_pk_bf16_f32 v121, v106, v107
    v_cvt_pk_bf16_f32 v122, v108, v109
    v_cvt_pk_bf16_f32 v123, v110, v111
    buffer_store_dwordx4 v[120:123], v183, s[12:15], s46 offen offset:0 sc1
    v_pk_mul_f32 v[136:137], v[48:49], v[48:49]
    v_pk_mul_f32 v[138:139], v[50:51], v[50:51]
    v_pk_mul_f32 v[140:141], v[52:53], v[52:53]
    v_pk_mul_f32 v[142:143], v[54:55], v[54:55]
    v_pk_fma_f32 v[136:137], v[136:137], v[174:175], v[176:177] op_sel_hi:[1,0,0]
    v_pk_fma_f32 v[138:139], v[138:139], v[174:175], v[176:177] op_sel_hi:[1,0,0]
    v_pk_fma_f32 v[140:141], v[140:141], v[174:175], v[176:177] op_sel_hi:[1,0,0]
    v_pk_fma_f32 v[142:143], v[142:143], v[174:175], v[176:177] op_sel_hi:[1,0,0]
    v_pk_mul_f32 v[136:137], v[136:137], v[48:49]
    v_pk_mul_f32 v[138:139], v[138:139], v[50:51]
    v_pk_mul_f32 v[140:141], v[140:141], v[52:53]
    v_pk_mul_f32 v[142:143], v[142:143], v[54:55]
    v_exp_f32 v136, v136
    v_exp_f32 v137, v137
    v_exp_f32 v138, v138
    v_exp_f32 v139, v139
    v_exp_f32 v140, v140
    v_exp_f32 v141, v141
    v_exp_f32 v142, v142
    v_exp_f32 v143, v143
    v_pk_fma_f32 v[136:137], v[136:137], v[178:179], v[178:179] op_sel:[0,0,0] op_sel_hi:[1,0,0]
    v_pk_fma_f32 v[138:139], v[138:139], v[178:179], v[178:179] op_sel:[0,0,0] op_sel_hi:[1,0,0]
    v_pk_fma_f32 v[140:141], v[140:141], v[178:179], v[178:179] op_sel:[0,0,0] op_sel_hi:[1,0,0]
    v_pk_fma_f32 v[142:143], v[142:143], v[178:179], v[178:179] op_sel:[0,0,0] op_sel_hi:[1,0,0]
    v_rcp_f32 v136, v136
    v_rcp_f32 v137, v137
    v_rcp_f32 v138, v138
    v_rcp_f32 v139, v139
    v_rcp_f32 v140, v140
    v_rcp_f32 v141, v141
    v_rcp_f32 v142, v142
    v_rcp_f32 v143, v143
    v_pk_mul_f32 v[136:137], v[136:137], v[48:49]
    v_pk_mul_f32 v[138:139], v[138:139], v[50:51]
    v_pk_mul_f32 v[140:141], v[140:141], v[52:53]
    v_pk_mul_f32 v[142:143], v[142:143], v[54:55]
    v_cvt_pk_bf16_f32 v128, v136, v137
    v_cvt_pk_bf16_f32 v129, v138, v139
    v_cvt_pk_bf16_f32 v130, v140, v141
    v_cvt_pk_bf16_f32 v131, v142, v143
    buffer_store_dwordx4 v[128:131], v183, s[12:15], s46 offen offset:1024 sc1
    v_pk_mul_f32 v[104:105], v[72:73], v[72:73]
    v_pk_mul_f32 v[106:107], v[74:75], v[74:75]
    v_pk_mul_f32 v[108:109], v[76:77], v[76:77]
    v_pk_mul_f32 v[110:111], v[78:79], v[78:79]
    v_pk_fma_f32 v[104:105], v[104:105], v[174:175], v[176:177] op_sel_hi:[1,0,0]
    v_pk_fma_f32 v[106:107], v[106:107], v[174:175], v[176:177] op_sel_hi:[1,0,0]
    v_pk_fma_f32 v[108:109], v[108:109], v[174:175], v[176:177] op_sel_hi:[1,0,0]
    v_pk_fma_f32 v[110:111], v[110:111], v[174:175], v[176:177] op_sel_hi:[1,0,0]
    v_pk_mul_f32 v[104:105], v[104:105], v[72:73]
    v_pk_mul_f32 v[106:107], v[106:107], v[74:75]
    v_pk_mul_f32 v[108:109], v[108:109], v[76:77]
    v_pk_mul_f32 v[110:111], v[110:111], v[78:79]
    v_exp_f32 v104, v104
    v_exp_f32 v105, v105
    v_exp_f32 v106, v106
    v_exp_f32 v107, v107
    v_exp_f32 v108, v108
    v_exp_f32 v109, v109
    v_exp_f32 v110, v110
    v_exp_f32 v111, v111
    v_pk_fma_f32 v[104:105], v[104:105], v[178:179], v[178:179] op_sel:[0,0,0] op_sel_hi:[1,0,0]
    v_pk_fma_f32 v[106:107], v[106:107], v[178:179], v[178:179] op_sel:[0,0,0] op_sel_hi:[1,0,0]
    v_pk_fma_f32 v[108:109], v[108:109], v[178:179], v[178:179] op_sel:[0,0,0] op_sel_hi:[1,0,0]
    v_pk_fma_f32 v[110:111], v[110:111], v[178:179], v[178:179] op_sel:[0,0,0] op_sel_hi:[1,0,0]
    v_rcp_f32 v104, v104
    v_rcp_f32 v105, v105
    v_rcp_f32 v106, v106
    v_rcp_f32 v107, v107
    v_rcp_f32 v108, v108
    v_rcp_f32 v109, v109
    v_rcp_f32 v110, v110
    v_rcp_f32 v111, v111
    v_pk_mul_f32 v[104:105], v[104:105], v[72:73]
    v_pk_mul_f32 v[106:107], v[106:107], v[74:75]
    v_pk_mul_f32 v[108:109], v[108:109], v[76:77]
    v_pk_mul_f32 v[110:111], v[110:111], v[78:79]
    v_cvt_pk_bf16_f32 v120, v104, v105
    v_cvt_pk_bf16_f32 v121, v106, v107
    v_cvt_pk_bf16_f32 v122, v108, v109
    v_cvt_pk_bf16_f32 v123, v110, v111
    buffer_store_dwordx4 v[120:123], v183, s[12:15], s46 offen offset:2048 sc1
    v_pk_mul_f32 v[136:137], v[80:81], v[80:81]
    v_pk_mul_f32 v[138:139], v[82:83], v[82:83]
    v_pk_mul_f32 v[140:141], v[84:85], v[84:85]
    v_pk_mul_f32 v[142:143], v[86:87], v[86:87]
    v_pk_fma_f32 v[136:137], v[136:137], v[174:175], v[176:177] op_sel_hi:[1,0,0]
    v_pk_fma_f32 v[138:139], v[138:139], v[174:175], v[176:177] op_sel_hi:[1,0,0]
    v_pk_fma_f32 v[140:141], v[140:141], v[174:175], v[176:177] op_sel_hi:[1,0,0]
    v_pk_fma_f32 v[142:143], v[142:143], v[174:175], v[176:177] op_sel_hi:[1,0,0]
    v_pk_mul_f32 v[136:137], v[136:137], v[80:81]
    v_pk_mul_f32 v[138:139], v[138:139], v[82:83]
    v_pk_mul_f32 v[140:141], v[140:141], v[84:85]
    v_pk_mul_f32 v[142:143], v[142:143], v[86:87]
    v_exp_f32 v136, v136
    v_exp_f32 v137, v137
    v_exp_f32 v138, v138
    v_exp_f32 v139, v139
    v_exp_f32 v140, v140
    v_exp_f32 v141, v141
    v_exp_f32 v142, v142
    v_exp_f32 v143, v143
    v_pk_fma_f32 v[136:137], v[136:137], v[178:179], v[178:179] op_sel:[0,0,0] op_sel_hi:[1,0,0]
    v_pk_fma_f32 v[138:139], v[138:139], v[178:179], v[178:179] op_sel:[0,0,0] op_sel_hi:[1,0,0]
    v_pk_fma_f32 v[140:141], v[140:141], v[178:179], v[178:179] op_sel:[0,0,0] op_sel_hi:[1,0,0]
    v_pk_fma_f32 v[142:143], v[142:143], v[178:179], v[178:179] op_sel:[0,0,0] op_sel_hi:[1,0,0]
    v_rcp_f32 v136, v136
    v_rcp_f32 v137, v137
    v_rcp_f32 v138, v138
    v_rcp_f32 v139, v139
    v_rcp_f32 v140, v140
    v_rcp_f32 v141, v141
    v_rcp_f32 v142, v142
    v_rcp_f32 v143, v143
    v_pk_mul_f32 v[136:137], v[136:137], v[80:81]
    v_pk_mul_f32 v[138:139], v[138:139], v[82:83]
    v_pk_mul_f32 v[140:141], v[140:141], v[84:85]
    v_pk_mul_f32 v[142:143], v[142:143], v[86:87]
    v_cvt_pk_bf16_f32 v128, v136, v137
    v_cvt_pk_bf16_f32 v129, v138, v139
    v_cvt_pk_bf16_f32 v130, v140, v141
    v_cvt_pk_bf16_f32 v131, v142, v143
    buffer_store_dwordx4 v[128:131], v183, s[12:15], s46 offen offset:3072 sc1
    v_and_b32 v1, 63, v0
    s_add_u32 m0, s39, 40960
    s_nop 0
    buffer_load_dwordx4 v250, s[20:23], s40 offen lds
    buffer_load_dwordx4 v251, s[20:23], s40 offen offset:1024 lds
    s_add_u32 s40, s40, 14336
    s_cmp_eq_u32 s40, s41
    s_cselect_b32 s40, s38, s40
    s_add_u32 m0, s39, 73728
    s_nop 0
    buffer_load_dwordx4 v250, s[20:23], s40 offen lds
    buffer_load_dwordx4 v251, s[20:23], s40 offen offset:1024 lds
    s_add_u32 s40, s40, 14336
    s_cmp_eq_u32 s40, s41
    s_cselect_b32 s40, s38, s40
    s_add_u32 m0, s39, 49152
    s_nop 0
    buffer_load_dwordx4 v250, s[20:23], s40 offen lds
    buffer_load_dwordx4 v251, s[20:23], s40 offen offset:1024 lds
    s_add_u32 s40, s40, 14336
    s_cmp_eq_u32 s40, s41
    s_cselect_b32 s40, s38, s40
    s_mov_b32 m0, s39
    s_nop 0
    buffer_load_dwordx4 v250, s[20:23], s40 offen lds
    buffer_load_dwordx4 v251, s[20:23], s40 offen offset:1024 lds
    s_add_u32 s40, s40, 14336
    s_cmp_eq_u32 s40, s41
    s_cselect_b32 s40, s38, s40
    s_add_u32 m0, s39, 8192
    s_nop 0
    buffer_load_dwordx4 v250, s[20:23], s40 offen lds
    buffer_load_dwordx4 v251, s[20:23], s40 offen offset:1024 lds
    s_add_u32 s40, s40, 14336
    s_cmp_eq_u32 s40, s41
    s_cselect_b32 s40, s38, s40
    s_add_u32 m0, s39, 57344
    s_nop 0
    buffer_load_dwordx4 v250, s[20:23], s40 offen lds
    buffer_load_dwordx4 v251, s[20:23], s40 offen offset:1024 lds
    s_add_u32 s40, s40, 14336
    s_cmp_eq_u32 s40, s41
    s_cselect_b32 s40, s38, s40
    v_mov_b32 v5, 0
    v_mov_b32 v6, s56
    s_lshl_b32 s45, s33, 1
    s_add_u32 s45, s45, s51
    s_mul_i32 s45, s45, 1152
    s_lshl_b32 s46, s34, 1
    s_add_u32 s46, s46, s50
    s_lshl_b32 s46, s46, 2
    s_add_u32 s45, s45, s46
    s_add_u32 s45, s45, 1998848
    s_waitcnt vmcnt(12)
    s_mov_b64 exec, 1
    buffer_store_dword v6, v5, s[12:15], s45 offen
    s_add_u32 s46, s45, 1933312
    buffer_store_dword v6, v5, s[12:15], s46 offen sc1
    s_mov_b64 exec, -1
    v_lshrrev_b32 v7, 4, v1
    v_bfe_u32 v8, v1, 2, 2
    v_and_b32 v9, 3, v1
    v_lshrrev_b32 v10, 5, v1
    v_lshrrev_b32 v2, 5, v1
    v_bfe_u32 v12, v1, 2, 2
    v_lshl_add_u32 v2, v2, 2, v12
    v_lshlrev_b32 v2, 7, v2
    v_bfe_u32 v3, v1, 3, 1
    v_lshl_add_u32 v2, v3, 6, v2
    v_bfe_u32 v3, v1, 4, 1
    v_lshl_add_u32 v2, v3, 5, v2
    v_and_b32 v3, 3, v1
    v_lshl_add_u32 v2, v3, 3, v2
    v_add_u32 v11, s39, v2
    s_lshr_b32 s45, s32, 1
    s_lshl_b32 s45, s45, 6
    v_xor_b32 v11, s45, v11
    v_xor_b32 v12, 64, v11
    v_add_u32 v13, 0x10000, v11
    v_add_u32 v14, 0x10000, v12
    v_lshl_add_u32 v2, v7, 2, v9
    v_mul_u32_u24 v224, 896, v2
    v_lshl_add_u32 v224, v8, 4, v224
    s_lshl_b32 s60, s61, 2
    s_add_u32 s60, s60, s32
    s_mul_i32 s60, s60, 14336
    s_lshl_b32 s45, s37, 7
    s_add_u32 s60, s60, s45
    v_lshlrev_b32 v244, 4, v8
    v_and_b32 v2, 31, v1
    v_mul_u32_u24 v224, 896, v2
    v_lshlrev_b32 v244, 4, v10
    v_add_u32 v224, v244, v224
    s_lshl_b32 s60, s61, 1
    s_and_b32 s45, s32, 1
    s_add_u32 s60, s60, s45
    s_mul_i32 s60, s60, 28672
    s_lshl_b32 s45, s37, 7
    s_add_u32 s60, s60, s45
    s_lshr_b32 s45, s32, 1
    s_lshl_b32 s45, s45, 6
    s_add_u32 s60, s60, s45
    v_mov_b32 v16, 0
    v_mov_b32 v17, 0
    v_mov_b32 v18, 0
    v_mov_b32 v19, 0
    v_mov_b32 v20, 0
    v_mov_b32 v21, 0
    v_mov_b32 v22, 0
    v_mov_b32 v23, 0
    v_mov_b32 v24, 0
    v_mov_b32 v25, 0
    v_mov_b32 v26, 0
    v_mov_b32 v27, 0
    v_mov_b32 v28, 0
    v_mov_b32 v29, 0
    v_mov_b32 v30, 0
    v_mov_b32 v31, 0
    v_mov_b32 v32, 0
    v_mov_b32 v33, 0
    v_mov_b32 v34, 0
    v_mov_b32 v35, 0
    v_mov_b32 v36, 0
    v_mov_b32 v37, 0
    v_mov_b32 v38, 0
    v_mov_b32 v39, 0
    v_mov_b32 v40, 0
    v_mov_b32 v41, 0
    v_mov_b32 v42, 0
    v_mov_b32 v43, 0
    v_mov_b32 v44, 0
    v_mov_b32 v45, 0
    v_mov_b32 v46, 0
    v_mov_b32 v47, 0
    v_mov_b32 v48, 0
    v_mov_b32 v49, 0
    v_mov_b32 v50, 0
    v_mov_b32 v51, 0
    v_mov_b32 v52, 0
    v_mov_b32 v53, 0
    v_mov_b32 v54, 0
    v_mov_b32 v55, 0
    v_mov_b32 v56, 0
    v_mov_b32 v57, 0
    v_mov_b32 v58, 0
    v_mov_b32 v59, 0
    v_mov_b32 v60, 0
    v_mov_b32 v61, 0
    v_mov_b32 v62, 0
    v_mov_b32 v63, 0
    v_mov_b32 v64, 0
    v_mov_b32 v65, 0
    v_mov_b32 v66, 0
    v_mov_b32 v67, 0
    v_mov_b32 v68, 0
    v_mov_b32 v69, 0
    v_mov_b32 v70, 0
    v_mov_b32 v71, 0
    v_mov_b32 v72, 0
    v_mov_b32 v73, 0
    v_mov_b32 v74, 0
    v_mov_b32 v75, 0
    v_mov_b32 v76, 0
    v_mov_b32 v77, 0
    v_mov_b32 v78, 0
    v_mov_b32 v79, 0
    v_lshlrev_b32 v2, 4, v1
    s_lshl_b32 s45, s61, 1
    s_mul_i32 s45, s45, 114688
    s_mul_i32 s46, s32, 28672
    s_add_u32 s45, s45, s46
    s_add_u32 s45, s45, 6291456
    v_add_u32 v245, s45, v2
    v_add_u32 v246, 114688, v245
    s_and_b32 s46, s32, 1
    s_mul_i32 s46, s46, 114688
    v_add_u32 v245, s46, v245
    v_subrev_u32 v246, s46, v246
    ds_read_b64_tr_b16 v[80:81], v11 offset:16384
    ds_read_b64_tr_b16 v[82:83], v11 offset:17408
    ds_read_b64_tr_b16 v[84:85], v12 offset:16384
    ds_read_b64_tr_b16 v[86:87], v12 offset:17408
    ds_read_b64_tr_b16 v[88:89], v11 offset:24576
    ds_read_b64_tr_b16 v[90:91], v11 offset:25600
    ds_read_b64_tr_b16 v[92:93], v12 offset:24576
    ds_read_b64_tr_b16 v[94:95], v12 offset:25600
    s_waitcnt lgkmcnt(4)
    s_add_u32 m0, s39, 16384
    s_nop 0
    buffer_load_dwordx4 v250, s[20:23], s40 offen lds
    buffer_load_dwordx4 v251, s[20:23], s40 offen offset:1024 lds
    s_add_u32 s40, s40, 14336
    s_cmp_eq_u32 s40, s41
    s_cselect_b32 s40, s38, s40
    ds_read_b64_tr_b16 v[96:97], v13 offset:0
    ds_read_b64_tr_b16 v[98:99], v13 offset:1024
    ds_read_b64_tr_b16 v[100:101], v14 offset:0
    ds_read_b64_tr_b16 v[102:103], v14 offset:1024
    s_waitcnt lgkmcnt(4)
    s_add_u32 m0, s39, 24576
    s_nop 0
    buffer_load_dwordx4 v250, s[20:23], s40 offen lds
    buffer_load_dwordx4 v251, s[20:23], s40 offen offset:1024 lds
    s_add_u32 s40, s40, 14336
    s_cmp_eq_u32 s40, s41
    s_cselect_b32 s40, s38, s40
    ds_read_b64_tr_b16 v[104:105], v11 offset:32768
    ds_read_b64_tr_b16 v[106:107], v11 offset:33792
    ds_read_b64_tr_b16 v[108:109], v12 offset:32768
    ds_read_b64_tr_b16 v[110:111], v12 offset:33792
    s_waitcnt lgkmcnt(4)
    s_add_u32 m0, s39, 65536
    s_nop 0
    buffer_load_dwordx4 v250, s[20:23], s40 offen lds
    buffer_load_dwordx4 v251, s[20:23], s40 offen offset:1024 lds
    s_add_u32 s40, s40, 14336
    s_cmp_eq_u32 s40, s41
    s_cselect_b32 s40, s38, s40
    s_waitcnt vmcnt(18)
    ds_read_b64_tr_b16 v[112:113], v11 offset:40960
    ds_read_b64_tr_b16 v[114:115], v11 offset:41984
    ds_read_b64_tr_b16 v[116:117], v12 offset:40960
    ds_read_b64_tr_b16 v[118:119], v12 offset:41984
    s_waitcnt lgkmcnt(4)
    s_add_u32 m0, s39, 32768
    s_nop 0
    buffer_load_dwordx4 v250, s[20:23], s40 offen lds
    buffer_load_dwordx4 v251, s[20:23], s40 offen offset:1024 lds
    s_add_u32 s40, s40, 14336
    s_cmp_eq_u32 s40, s41
    s_cselect_b32 s40, s38, s40
    s_waitcnt vmcnt(18)
    ds_read_b64_tr_b16 v[120:121], v13 offset:8192
    ds_read_b64_tr_b16 v[122:123], v13 offset:9216
    ds_read_b64_tr_b16 v[124:125], v14 offset:8192
    ds_read_b64_tr_b16 v[126:127], v14 offset:9216
    s_waitcnt lgkmcnt(4)
    s_add_u32 m0, s39, 40960
    s_nop 0
    buffer_load_dwordx4 v250, s[20:23], s40 offen lds
    buffer_load_dwordx4 v251, s[20:23], s40 offen offset:1024 lds
    s_add_u32 s40, s40, 14336
    s_cmp_eq_u32 s40, s41
    s_cselect_b32 s40, s38, s40
    s_waitcnt vmcnt(18)
    ds_read_b64_tr_b16 v[128:129], v11 offset:49152
    ds_read_b64_tr_b16 v[130:131], v11 offset:50176
    ds_read_b64_tr_b16 v[132:133], v12 offset:49152
    ds_read_b64_tr_b16 v[134:135], v12 offset:50176
    s_waitcnt lgkmcnt(4)
    s_add_u32 m0, s39, 73728
    s_nop 0
    buffer_load_dwordx4 v250, s[20:23], s40 offen lds
    buffer_load_dwordx4 v251, s[20:23], s40 offen offset:1024 lds
    s_add_u32 s40, s40, 14336
    s_cmp_eq_u32 s40, s41
    s_cselect_b32 s40, s38, s40
    s_waitcnt vmcnt(18)
    ds_read_b64_tr_b16 v[136:137], v11 offset:0
    ds_read_b64_tr_b16 v[138:139], v11 offset:1024
    ds_read_b64_tr_b16 v[140:141], v12 offset:0
    ds_read_b64_tr_b16 v[142:143], v12 offset:1024
    s_waitcnt lgkmcnt(4)
    s_add_u32 m0, s39, 49152
    s_nop 0
    buffer_load_dwordx4 v250, s[20:23], s40 offen lds
    buffer_load_dwordx4 v251, s[20:23], s40 offen offset:1024 lds
    s_add_u32 s40, s40, 14336
    s_cmp_eq_u32 s40, s41
    s_cselect_b32 s40, s38, s40
    s_waitcnt vmcnt(18)
    ds_read_b64_tr_b16 v[144:145], v11 offset:8192
    ds_read_b64_tr_b16 v[146:147], v11 offset:9216
    ds_read_b64_tr_b16 v[148:149], v12 offset:8192
    ds_read_b64_tr_b16 v[150:151], v12 offset:9216
    s_waitcnt lgkmcnt(4)
    v_and_b32 v5, 63, v0
    v_lshlrev_b32 v5, 2, v5
    s_mul_i32 s43, s61, 1152
    s_mul_i32 s46, s32, 28
    s_add_u32 s43, s43, s46
    s_add_u32 s43, s43, 1998848
    s_mov_b64 exec, 127
    buffer_load_dword v6, v5, s[12:15], s43 offen sc1
    s_mov_b64 exec, -1
    s_mov_b32 m0, s39
    s_nop 0
    buffer_load_dwordx4 v250, s[20:23], s40 offen lds
    buffer_load_dwordx4 v251, s[20:23], s40 offen offset:1024 lds
    s_add_u32 s40, s40, 14336
    s_cmp_eq_u32 s40, s41
    s_cselect_b32 s40, s38, s40
    s_waitcnt vmcnt(19)
    ds_read_b64_tr_b16 v[152:153], v11 offset:57344
    ds_read_b64_tr_b16 v[154:155], v11 offset:58368
    ds_read_b64_tr_b16 v[156:157], v12 offset:57344
    ds_read_b64_tr_b16 v[158:159], v12 offset:58368
    s_waitcnt lgkmcnt(4)
    s_add_u32 m0, s39, 8192
    s_nop 0
    buffer_load_dwordx4 v250, s[20:23], s40 offen lds
    buffer_load_dwordx4 v251, s[20:23], s40 offen offset:1024 lds
    s_add_u32 s40, s40, 14336
    s_cmp_eq_u32 s40, s41
    s_cselect_b32 s40, s38, s40
    s_waitcnt vmcnt(17)
    ds_read_b64_tr_b16 v[160:161], v11 offset:16384
    ds_read_b64_tr_b16 v[162:163], v11 offset:17408
    ds_read_b64_tr_b16 v[164:165], v12 offset:16384
    ds_read_b64_tr_b16 v[166:167], v12 offset:17408
    s_waitcnt lgkmcnt(4)
    s_add_u32 m0, s39, 57344
    s_nop 0
    buffer_load_dwordx4 v250, s[20:23], s40 offen lds
    buffer_load_dwordx4 v251, s[20:23], s40 offen offset:1024 lds
    s_add_u32 s40, s40, 14336
    s_cmp_eq_u32 s40, s41
    s_cselect_b32 s40, s38, s40
    s_waitcnt vmcnt(17)
    ds_read_b64_tr_b16 v[168:169], v11 offset:24576
    ds_read_b64_tr_b16 v[170:171], v11 offset:25600
    ds_read_b64_tr_b16 v[172:173], v12 offset:24576
    ds_read_b64_tr_b16 v[174:175], v12 offset:25600
    s_waitcnt lgkmcnt(4)
    s_add_u32 m0, s39, 16384
    s_nop 0
    buffer_load_dwordx4 v250, s[20:23], s40 offen lds
    buffer_load_dwordx4 v251, s[20:23], s40 offen offset:1024 lds
    s_add_u32 s40, s40, 14336
    s_cmp_eq_u32 s40, s41
    s_cselect_b32 s40, s38, s40
    s_waitcnt lgkmcnt(0)
    s_add_u32 m0, s39, 24576
    s_nop 0
    buffer_load_dwordx4 v250, s[20:23], s40 offen lds
    buffer_load_dwordx4 v251, s[20:23], s40 offen offset:1024 lds
    s_add_u32 s40, s40, 14336
    s_cmp_eq_u32 s40, s41
    s_cselect_b32 s40, s38, s40
    v_lshrrev_b32 v2, 3, v1
    v_lshlrev_b32 v254, 12, v2
    s_and_b32 s45, s32, 1
    s_lshl_b32 s45, s45, 2
    v_bfe_u32 v3, v1, 4, 1
    v_or_b32 v3, s45, v3
    v_and_b32 v4, 7, v1
    v_xor_b32 v3, v3, v4
    v_lshl_add_u32 v254, v3, 4, v254
    v_xor_b32 v255, 32, v254
    s_waitcnt vmcnt(10)
    s_mov_b64 exec, 0x7f
    v_cmp_ne_u32 vcc, s56, v6
    s_mov_b64 exec, -1
    s_cmp_eq_u64 vcc, 0
    s_cbranch_scc0 G2B_17
    s_mov_b32 s62, s42
    buffer_load_dwordx4 v[176:179], v245, s[12:15], s62 offen offset:0 sc1
    buffer_load_dwordx4 v[180:183], v246, s[12:15], s62 offen offset:0 sc1
    buffer_load_dwordx4 v[184:187], v245, s[12:15], s62 offen offset:1024 sc1
    buffer_load_dwordx4 v[188:191], v246, s[12:15], s62 offen offset:1024 sc1
    buffer_load_dwordx4 v[192:195], v245, s[12:15], s62 offen offset:2048 sc1
    buffer_load_dwordx4 v[196:199], v246, s[12:15], s62 offen offset:2048 sc1
    buffer_load_dwordx4 v[200:203], v245, s[12:15], s62 offen offset:3072 sc1
    buffer_load_dwordx4 v[204:207], v246, s[12:15], s62 offen offset:3072 sc1
    s_add_u32 s62, s62, 4096
    s_cmp_eq_u32 s62, 28672
    s_cselect_b32 s62, 0, s62
    buffer_load_dwordx4 v[208:211], v245, s[12:15], s62 offen offset:0 sc1
    buffer_load_dwordx4 v[212:215], v246, s[12:15], s62 offen offset:0 sc1
    buffer_load_dwordx4 v[216:219], v245, s[12:15], s62 offen offset:1024 sc1
    buffer_load_dwordx4 v[220:223], v246, s[12:15], s62 offen offset:1024 sc1
    s_waitcnt vmcnt(10)
    v_mfma_f32_32x32x16_bf16 v[16:31], v[80:83], v[176:179], v[16:31]
    v_mfma_f32_32x32x16_bf16 v[48:63], v[84:87], v[176:179], v[48:63]
    buffer_load_dwordx4 v[176:179], v245, s[12:15], s62 offen offset:2048 sc1
    v_mfma_f32_32x32x16_bf16 v[32:47], v[80:83], v[180:183], v[32:47]
    v_mfma_f32_32x32x16_bf16 v[64:79], v[84:87], v[180:183], v[64:79]
    buffer_load_dwordx4 v[180:183], v246, s[12:15], s62 offen offset:2048 sc1
    s_waitcnt vmcnt(10)
    v_mfma_f32_32x32x16_bf16 v[16:31], v[88:91], v[184:187], v[16:31]
    ds_read_b64_tr_b16 v[80:81], v13 offset:0
    ds_read_b64_tr_b16 v[82:83], v13 offset:1024
    ds_read_b64_tr_b16 v[84:85], v14 offset:0
    ds_read_b64_tr_b16 v[86:87], v14 offset:1024
    v_mfma_f32_32x32x16_bf16 v[48:63], v[92:95], v[184:187], v[48:63]
    buffer_load_dwordx4 v[184:187], v245, s[12:15], s62 offen offset:3072 sc1
    v_mfma_f32_32x32x16_bf16 v[32:47], v[88:91], v[188:191], v[32:47]
    v_mfma_f32_32x32x16_bf16 v[64:79], v[92:95], v[188:191], v[64:79]
    buffer_load_dwordx4 v[188:191], v246, s[12:15], s62 offen offset:3072 sc1
    s_waitcnt vmcnt(10)
    v_mfma_f32_32x32x16_bf16 v[16:31], v[96:99], v[192:195], v[16:31]
    ds_read_b64_tr_b16 v[88:89], v11 offset:32768
    ds_read_b64_tr_b16 v[90:91], v11 offset:33792
    ds_read_b64_tr_b16 v[92:93], v12 offset:32768
    ds_read_b64_tr_b16 v[94:95], v12 offset:33792
    v_mfma_f32_32x32x16_bf16 v[48:63], v[100:103], v[192:195], v[48:63]
    s_add_u32 s62, s62, 4096
    s_cmp_eq_u32 s62, 28672
    s_cselect_b32 s62, 0, s62
    buffer_load_dwordx4 v[192:195], v245, s[12:15], s62 offen offset:0 sc1
    v_mfma_f32_32x32x16_bf16 v[32:47], v[96:99], v[196:199], v[32:47]
    s_waitcnt lgkmcnt(4)
    s_add_u32 m0, s39, 65536
    s_nop 0
    buffer_load_dwordx4 v250, s[20:23], s40 offen lds
    buffer_load_dwordx4 v251, s[20:23], s40 offen offset:1024 lds
    s_add_u32 s40, s40, 14336
    s_cmp_eq_u32 s40, s41
    s_cselect_b32 s40, s38, s40
    v_mfma_f32_32x32x16_bf16 v[64:79], v[100:103], v[196:199], v[64:79]
    buffer_load_dwordx4 v[196:199], v246, s[12:15], s62 offen offset:0 sc1
    s_waitcnt vmcnt(12)
    v_mfma_f32_32x32x16_bf16 v[16:31], v[104:107], v[200:203], v[16:31]
    ds_read_b64_tr_b16 v[96:97], v11 offset:40960
    ds_read_b64_tr_b16 v[98:99], v11 offset:41984
    ds_read_b64_tr_b16 v[100:101], v12 offset:40960
    ds_read_b64_tr_b16 v[102:103], v12 offset:41984
    v_mfma_f32_32x32x16_bf16 v[48:63], v[108:111], v[200:203], v[48:63]
    buffer_load_dwordx4 v[200:203], v245, s[12:15], s62 offen offset:1024 sc1
    v_mfma_f32_32x32x16_bf16 v[32:47], v[104:107], v[204:207], v[32:47]
    s_waitcnt lgkmcnt(4)
    s_add_u32 m0, s39, 32768
    s_nop 0
    buffer_load_dwordx4 v250, s[20:23], s40 offen lds
    buffer_load_dwordx4 v251, s[20:23], s40 offen offset:1024 lds
    s_add_u32 s40, s40, 14336
    s_cmp_eq_u32 s40, s41
    s_cselect_b32 s40, s38, s40
    v_mfma_f32_32x32x16_bf16 v[64:79], v[108:111], v[204:207], v[64:79]
    buffer_load_dwordx4 v[204:207], v246, s[12:15], s62 offen offset:1024 sc1
    s_waitcnt vmcnt(14)
    v_mfma_f32_32x32x16_bf16 v[16:31], v[112:115], v[208:211], v[16:31]
    ds_read_b64_tr_b16 v[104:105], v13 offset:8192
    ds_read_b64_tr_b16 v[106:107], v13 offset:9216
    ds_read_b64_tr_b16 v[108:109], v14 offset:8192
    ds_read_b64_tr_b16 v[110:111], v14 offset:9216
    v_mfma_f32_32x32x16_bf16 v[48:63], v[116:119], v[208:211], v[48:63]
    buffer_load_dwordx4 v[208:211], v245, s[12:15], s62 offen offset:2048 sc1
    v_mfma_f32_32x32x16_bf16 v[32:47], v[112:115], v[212:215], v[32:47]
    s_waitcnt lgkmcnt(4)
    s_add_u32 m0, s39, 40960
    s_nop 0
    buffer_load_dwordx4 v250, s[20:23], s40 offen lds
    buffer_load_dwordx4 v251, s[20:23], s40 offen offset:1024 lds
    s_add_u32 s40, s40, 14336
    s_cmp_eq_u32 s40, s41
    s_cselect_b32 s40, s38, s40
    v_mfma_f32_32x32x16_bf16 v[64:79], v[116:119], v[212:215], v[64:79]
    buffer_load_dwordx4 v[212:215], v246, s[12:15], s62 offen offset:2048 sc1
    s_waitcnt vmcnt(16)
    v_mfma_f32_32x32x16_bf16 v[16:31], v[120:123], v[216:219], v[16:31]
    ds_read_b64_tr_b16 v[112:113], v11 offset:49152
    ds_read_b64_tr_b16 v[114:115], v11 offset:50176
    ds_read_b64_tr_b16 v[116:117], v12 offset:49152
    ds_read_b64_tr_b16 v[118:119], v12 offset:50176
    v_mfma_f32_32x32x16_bf16 v[48:63], v[124:127], v[216:219], v[48:63]
    buffer_load_dwordx4 v[216:219], v245, s[12:15], s62 offen offset:3072 sc1
    v_mfma_f32_32x32x16_bf16 v[32:47], v[120:123], v[220:223], v[32:47]
    s_waitcnt lgkmcnt(4)
    s_add_u32 m0, s39, 73728
    s_nop 0
    buffer_load_dwordx4 v250, s[20:23], s40 offen lds
    buffer_load_dwordx4 v251, s[20:23], s40 offen offset:1024 lds
    s_add_u32 s40, s40, 14336
    s_cmp_eq_u32 s40, s41
    s_cselect_b32 s40, s38, s40
    v_mfma_f32_32x32x16_bf16 v[64:79], v[124:127], v[220:223], v[64:79]
    buffer_load_dwordx4 v[220:223], v246, s[12:15], s62 offen offset:3072 sc1
    s_waitcnt vmcnt(18)
    v_mfma_f32_32x32x16_bf16 v[16:31], v[128:131], v[176:179], v[16:31]
    ds_read_b64_tr_b16 v[120:121], v11 offset:0
    ds_read_b64_tr_b16 v[122:123], v11 offset:1024
    ds_read_b64_tr_b16 v[124:125], v12 offset:0
    ds_read_b64_tr_b16 v[126:127], v12 offset:1024
    v_mfma_f32_32x32x16_bf16 v[48:63], v[132:135], v[176:179], v[48:63]
    s_add_u32 s62, s62, 4096
    s_cmp_eq_u32 s62, 28672
    s_cselect_b32 s62, 0, s62
    buffer_load_dwordx4 v[176:179], v245, s[12:15], s62 offen offset:0 sc1
    v_mfma_f32_32x32x16_bf16 v[32:47], v[128:131], v[180:183], v[32:47]
    s_waitcnt lgkmcnt(4)
    s_add_u32 m0, s39, 49152
    s_nop 0
    buffer_load_dwordx4 v250, s[20:23], s40 offen lds
    buffer_load_dwordx4 v251, s[20:23], s40 offen offset:1024 lds
    s_add_u32 s40, s40, 14336
    s_cmp_eq_u32 s40, s41
    s_cselect_b32 s40, s38, s40
    v_mfma_f32_32x32x16_bf16 v[64:79], v[132:135], v[180:183], v[64:79]
    buffer_load_dwordx4 v[180:183], v246, s[12:15], s62 offen offset:0 sc1
    s_waitcnt vmcnt(20)
    v_mfma_f32_32x32x16_bf16 v[16:31], v[136:139], v[184:187], v[16:31]
    ds_read_b64_tr_b16 v[128:129], v11 offset:8192
    ds_read_b64_tr_b16 v[130:131], v11 offset:9216
    ds_read_b64_tr_b16 v[132:133], v12 offset:8192
    ds_read_b64_tr_b16 v[134:135], v12 offset:9216
    v_mfma_f32_32x32x16_bf16 v[48:63], v[140:143], v[184:187], v[48:63]
    buffer_load_dwordx4 v[184:187], v245, s[12:15], s62 offen offset:1024 sc1
    v_mfma_f32_32x32x16_bf16 v[32:47], v[136:139], v[188:191], v[32:47]
    s_waitcnt lgkmcnt(4)
    s_mov_b32 m0, s39
    s_nop 0
    buffer_load_dwordx4 v250, s[20:23], s40 offen lds
    buffer_load_dwordx4 v251, s[20:23], s40 offen offset:1024 lds
    s_add_u32 s40, s40, 14336
    s_cmp_eq_u32 s40, s41
    s_cselect_b32 s40, s38, s40
    v_mfma_f32_32x32x16_bf16 v[64:79], v[140:143], v[188:191], v[64:79]
    buffer_load_dwordx4 v[188:191], v246, s[12:15], s62 offen offset:1024 sc1
    s_waitcnt vmcnt(20)
    v_mfma_f32_32x32x16_bf16 v[16:31], v[144:147], v[192:195], v[16:31]
    ds_read_b64_tr_b16 v[136:137], v11 offset:57344
    ds_read_b64_tr_b16 v[138:139], v11 offset:58368
    ds_read_b64_tr_b16 v[140:141], v12 offset:57344
    ds_read_b64_tr_b16 v[142:143], v12 offset:58368
    v_mfma_f32_32x32x16_bf16 v[48:63], v[148:151], v[192:195], v[48:63]
    buffer_load_dwordx4 v[192:195], v245, s[12:15], s62 offen offset:2048 sc1
    v_mfma_f32_32x32x16_bf16 v[32:47], v[144:147], v[196:199], v[32:47]
    v_mfma_f32_32x32x16_bf16 v[64:79], v[148:151], v[196:199], v[64:79]
    buffer_load_dwordx4 v[196:199], v246, s[12:15], s62 offen offset:2048 sc1
    s_waitcnt vmcnt(18)
    v_mfma_f32_32x32x16_bf16 v[16:31], v[152:155], v[200:203], v[16:31]
    ds_read_b64_tr_b16 v[144:145], v11 offset:16384
    ds_read_b64_tr_b16 v[146:147], v11 offset:17408
    ds_read_b64_tr_b16 v[148:149], v12 offset:16384
    ds_read_b64_tr_b16 v[150:151], v12 offset:17408
    v_mfma_f32_32x32x16_bf16 v[48:63], v[156:159], v[200:203], v[48:63]
    buffer_load_dwordx4 v[200:203], v245, s[12:15], s62 offen offset:3072 sc1
    v_mfma_f32_32x32x16_bf16 v[32:47], v[152:155], v[204:207], v[32:47]
    v_mfma_f32_32x32x16_bf16 v[64:79], v[156:159], v[204:207], v[64:79]
    buffer_load_dwordx4 v[204:207], v246, s[12:15], s62 offen offset:3072 sc1
    s_waitcnt vmcnt(16)
    v_mfma_f32_32x32x16_bf16 v[16:31], v[160:163], v[208:211], v[16:31]
    ds_read_b64_tr_b16 v[152:153], v11 offset:24576
    ds_read_b64_tr_b16 v[154:155], v11 offset:25600
    ds_read_b64_tr_b16 v[156:157], v12 offset:24576
    ds_read_b64_tr_b16 v[158:159], v12 offset:25600
    v_mfma_f32_32x32x16_bf16 v[48:63], v[164:167], v[208:211], v[48:63]
    s_add_u32 s62, s62, 4096
    s_cmp_eq_u32 s62, 28672
    s_cselect_b32 s62, 0, s62
    buffer_load_dwordx4 v[208:211], v245, s[12:15], s62 offen offset:0 sc1
    v_mfma_f32_32x32x16_bf16 v[32:47], v[160:163], v[212:215], v[32:47]
    v_mfma_f32_32x32x16_bf16 v[64:79], v[164:167], v[212:215], v[64:79]
    buffer_load_dwordx4 v[212:215], v246, s[12:15], s62 offen offset:0 sc1
    s_waitcnt vmcnt(14)
    v_mfma_f32_32x32x16_bf16 v[16:31], v[168:171], v[216:219], v[16:31]
    ds_read_b64_tr_b16 v[160:161], v13 offset:0
    ds_read_b64_tr_b16 v[162:163], v13 offset:1024
    ds_read_b64_tr_b16 v[164:165], v14 offset:0
    ds_read_b64_tr_b16 v[166:167], v14 offset:1024
    v_mfma_f32_32x32x16_bf16 v[48:63], v[172:175], v[216:219], v[48:63]
    buffer_load_dwordx4 v[216:219], v245, s[12:15], s62 offen offset:1024 sc1
    v_mfma_f32_32x32x16_bf16 v[32:47], v[168:171], v[220:223], v[32:47]
    v_mfma_f32_32x32x16_bf16 v[64:79], v[172:175], v[220:223], v[64:79]
    buffer_load_dwordx4 v[220:223], v246, s[12:15], s62 offen offset:1024 sc1
    s_waitcnt vmcnt(12)
    v_mfma_f32_32x32x16_bf16 v[16:31], v[80:83], v[176:179], v[16:31]
    ds_read_b64_tr_b16 v[168:169], v11 offset:32768
    ds_read_b64_tr_b16 v[170:171], v11 offset:33792
    ds_read_b64_tr_b16 v[172:173], v12 offset:32768
    ds_read_b64_tr_b16 v[174:175], v12 offset:33792
    v_mfma_f32_32x32x16_bf16 v[48:63], v[84:87], v[176:179], v[48:63]
    buffer_load_dwordx4 v[176:179], v245, s[12:15], s62 offen offset:2048 sc1
    v_mfma_f32_32x32x16_bf16 v[32:47], v[80:83], v[180:183], v[32:47]
    v_mfma_f32_32x32x16_bf16 v[64:79], v[84:87], v[180:183], v[64:79]
    buffer_load_dwordx4 v[180:183], v246, s[12:15], s62 offen offset:2048 sc1
    s_waitcnt vmcnt(10)
    v_mfma_f32_32x32x16_bf16 v[16:31], v[88:91], v[184:187], v[16:31]
    ds_read_b64_tr_b16 v[80:81], v11 offset:40960
    ds_read_b64_tr_b16 v[82:83], v11 offset:41984
    ds_read_b64_tr_b16 v[84:85], v12 offset:40960
    ds_read_b64_tr_b16 v[86:87], v12 offset:41984
    v_mfma_f32_32x32x16_bf16 v[48:63], v[92:95], v[184:187], v[48:63]
    buffer_load_dwordx4 v[184:187], v245, s[12:15], s62 offen offset:3072 sc1
    v_mfma_f32_32x32x16_bf16 v[32:47], v[88:91], v[188:191], v[32:47]
    v_mfma_f32_32x32x16_bf16 v[64:79], v[92:95], v[188:191], v[64:79]
    buffer_load_dwordx4 v[188:191], v246, s[12:15], s62 offen offset:3072 sc1
    s_waitcnt vmcnt(10)
    v_mfma_f32_32x32x16_bf16 v[16:31], v[96:99], v[192:195], v[16:31]
    ds_read_b64_tr_b16 v[88:89], v13 offset:8192
    ds_read_b64_tr_b16 v[90:91], v13 offset:9216
    ds_read_b64_tr_b16 v[92:93], v14 offset:8192
    ds_read_b64_tr_b16 v[94:95], v14 offset:9216
    v_mfma_f32_32x32x16_bf16 v[48:63], v[100:103], v[192:195], v[48:63]
    s_add_u32 s62, s62, 4096
    s_cmp_eq_u32 s62, 28672
    s_cselect_b32 s62, 0, s62
    buffer_load_dwordx4 v[192:195], v245, s[12:15], s62 offen offset:0 sc1
    v_mfma_f32_32x32x16_bf16 v[32:47], v[96:99], v[196:199], v[32:47]
    v_mfma_f32_32x32x16_bf16 v[64:79], v[100:103], v[196:199], v[64:79]
    buffer_load_dwordx4 v[196:199], v246, s[12:15], s62 offen offset:0 sc1
    s_waitcnt vmcnt(10)
    v_mfma_f32_32x32x16_bf16 v[16:31], v[104:107], v[200:203], v[16:31]
    ds_read_b64_tr_b16 v[96:97], v11 offset:49152
    ds_read_b64_tr_b16 v[98:99], v11 offset:50176
    ds_read_b64_tr_b16 v[100:101], v12 offset:49152
    ds_read_b64_tr_b16 v[102:103], v12 offset:50176
    v_mfma_f32_32x32x16_bf16 v[48:63], v[108:111], v[200:203], v[48:63]
    buffer_load_dwordx4 v[200:203], v245, s[12:15], s62 offen offset:1024 sc1
    v_mfma_f32_32x32x16_bf16 v[32:47], v[104:107], v[204:207], v[32:47]
    v_mfma_f32_32x32x16_bf16 v[64:79], v[108:111], v[204:207], v[64:79]
    buffer_load_dwordx4 v[204:207], v246, s[12:15], s62 offen offset:1024 sc1
    s_waitcnt vmcnt(10)
    v_mfma_f32_32x32x16_bf16 v[16:31], v[112:115], v[208:211], v[16:31]
    ds_read_b64_tr_b16 v[104:105], v11 offset:0
    ds_read_b64_tr_b16 v[106:107], v11 offset:1024
    ds_read_b64_tr_b16 v[108:109], v12 offset:0
    ds_read_b64_tr_b16 v[110:111], v12 offset:1024
    v_mfma_f32_32x32x16_bf16 v[48:63], v[116:119], v[208:211], v[48:63]
    buffer_load_dwordx4 v[208:211], v245, s[12:15], s62 offen offset:2048 sc1
    v_mfma_f32_32x32x16_bf16 v[32:47], v[112:115], v[212:215], v[32:47]
    v_mfma_f32_32x32x16_bf16 v[64:79], v[116:119], v[212:215], v[64:79]
    buffer_load_dwordx4 v[212:215], v246, s[12:15], s62 offen offset:2048 sc1
    v_and_b32 v5, 63, v0
    v_lshlrev_b32 v5, 2, v5
    s_lshl_b32 s45, s37, 1
    s_lshr_b32 s46, s61, 4
    s_add_u32 s45, s45, s46
    s_mul_i32 s45, s45, 2304
    s_lshl_b32 s46, s32, 6
    s_add_u32 s45, s45, s46
    s_add_u32 s45, s45, 2048000
    s_mov_b64 exec, 0xffff
    buffer_load_dword v6, v5, s[12:15], s45 offen sc1
    s_mov_b64 exec, -1
    s_waitcnt vmcnt(11)
    v_mfma_f32_32x32x16_bf16 v[16:31], v[120:123], v[216:219], v[16:31]
    v_mfma_f32_32x32x16_bf16 v[48:63], v[124:127], v[216:219], v[48:63]
    buffer_load_dwordx4 v[216:219], v245, s[12:15], s62 offen offset:3072 sc1
    v_mfma_f32_32x32x16_bf16 v[32:47], v[120:123], v[220:223], v[32:47]
    v_mfma_f32_32x32x16_bf16 v[64:79], v[124:127], v[220:223], v[64:79]
    buffer_load_dwordx4 v[220:223], v246, s[12:15], s62 offen offset:3072 sc1
    s_waitcnt vmcnt(11) lgkmcnt(15)
    v_mfma_f32_32x32x16_bf16 v[16:31], v[128:131], v[176:179], v[16:31]
    v_mfma_f32_32x32x16_bf16 v[48:63], v[132:135], v[176:179], v[48:63]
    s_add_u32 s62, s62, 4096
    s_cmp_eq_u32 s62, 28672
    s_cselect_b32 s62, 0, s62
    buffer_load_dwordx4 v[176:179], v245, s[12:15], s62 offen offset:0 sc1
    v_mfma_f32_32x32x16_bf16 v[32:47], v[128:131], v[180:183], v[32:47]
    v_mfma_f32_32x32x16_bf16 v[64:79], v[132:135], v[180:183], v[64:79]
    buffer_load_dwordx4 v[180:183], v246, s[12:15], s62 offen offset:0 sc1
    s_waitcnt vmcnt(11)
    v_mfma_f32_32x32x16_bf16 v[16:31], v[136:139], v[184:187], v[16:31]
    v_mfma_f32_32x32x16_bf16 v[48:63], v[140:143], v[184:187], v[48:63]
    buffer_load_dwordx4 v[184:187], v245, s[12:15], s62 offen offset:1024 sc1
    v_mfma_f32_32x32x16_bf16 v[32:47], v[136:139], v[188:191], v[32:47]
    v_mfma_f32_32x32x16_bf16 v[64:79], v[140:143], v[188:191], v[64:79]
    buffer_load_dwordx4 v[188:191], v246, s[12:15], s62 offen offset:1024 sc1
    s_waitcnt vmcnt(11)
    v_mfma_f32_32x32x16_bf16 v[16:31], v[144:147], v[192:195], v[16:31]
    v_mfma_f32_32x32x16_bf16 v[48:63], v[148:151], v[192:195], v[48:63]
    buffer_load_dwordx4 v[192:195], v245, s[12:15], s62 offen offset:2048 sc1
    v_mfma_f32_32x32x16_bf16 v[32:47], v[144:147], v[196:199], v[32:47]
    v_mfma_f32_32x32x16_bf16 v[64:79], v[148:151], v[196:199], v[64:79]
    buffer_load_dwordx4 v[196:199], v246, s[12:15], s62 offen offset:2048 sc1
    s_waitcnt vmcnt(11)
    v_mfma_f32_32x32x16_bf16 v[16:31], v[152:155], v[200:203], v[16:31]
    v_mfma_f32_32x32x16_bf16 v[48:63], v[156:159], v[200:203], v[48:63]
    buffer_load_dwordx4 v[200:203], v245, s[12:15], s62 offen offset:3072 sc1
    v_mfma_f32_32x32x16_bf16 v[32:47], v[152:155], v[204:207], v[32:47]
    v_mfma_f32_32x32x16_bf16 v[64:79], v[156:159], v[204:207], v[64:79]
    buffer_load_dwordx4 v[204:207], v246, s[12:15], s62 offen offset:3072 sc1
    s_lshl_b32 s45, s37, 7
    s_lshr_b32 s46, s32, 1
    s_lshl_b32 s46, s46, 6
    s_add_u32 s45, s45, s46
    buffer_load_dwordx4 v[228:231], v224, s[4:7], s60 offen
    buffer_load_dwordx4 v[232:235], v224, s[4:7], s60 offen offset:32
    buffer_load_dwordx4 v[236:239], v244, s[28:31], s45 offen
    buffer_load_dwordx4 v[240:243], v244, s[28:31], s45 offen offset:32
    s_waitcnt vmcnt(15)
    v_mfma_f32_32x32x16_bf16 v[16:31], v[160:163], v[208:211], v[16:31]
    v_mfma_f32_32x32x16_bf16 v[48:63], v[164:167], v[208:211], v[48:63]
    v_mfma_f32_32x32x16_bf16 v[32:47], v[160:163], v[212:215], v[32:47]
    v_mfma_f32_32x32x16_bf16 v[64:79], v[164:167], v[212:215], v[64:79]
    s_waitcnt vmcnt(14)
    s_mov_b64 exec, 0xffff
    v_cmp_ne_u32 vcc, s56, v6
    s_mov_b64 exec, -1
    s_cmp_eq_u64 vcc, 0
    s_cselect_b32 s44, 1, 0
    s_lshl_b32 s45, s37, 2
    s_add_u32 s45, s45, s32
    s_lshl_b32 s45, s45, 16
    s_lshl_b32 s46, s61, 7
    s_add_u32 s45, s45, s46
    s_add_u32 s45, s45, 4194304
    s_add_u32 s46, s45, 32768
    s_cmp_eq_u32 s44, 0
    s_cbranch_scc1 G2S0_19
    s_add_u32 m0, s39, 65536
    s_nop 0
    buffer_load_dwordx4 v254, s[12:15], s45 offen sc1 lds
    s_add_u32 m0, s39, 66560
    s_nop 0
    buffer_load_dwordx4 v255, s[12:15], s46 offen sc1 lds
    s_branch G2S1_20
G2S0_19:
    buffer_load_dword v6, v5, s[12:15], s45 offen
    buffer_load_dword v6, v5, s[12:15], s45 offen
G2S1_20:
    s_waitcnt vmcnt(14)
    v_mfma_f32_32x32x16_bf16 v[16:31], v[168:171], v[216:219], v[16:31]
    v_mfma_f32_32x32x16_bf16 v[48:63], v[172:175], v[216:219], v[48:63]
    v_mfma_f32_32x32x16_bf16 v[32:47], v[168:171], v[220:223], v[32:47]
    v_mfma_f32_32x32x16_bf16 v[64:79], v[172:175], v[220:223], v[64:79]
    s_waitcnt vmcnt(12) lgkmcnt(12)
    v_mfma_f32_32x32x16_bf16 v[16:31], v[80:83], v[176:179], v[16:31]
    v_mfma_f32_32x32x16_bf16 v[48:63], v[84:87], v[176:179], v[48:63]
    v_mfma_f32_32x32x16_bf16 v[32:47], v[80:83], v[180:183], v[32:47]
    v_mfma_f32_32x32x16_bf16 v[64:79], v[84:87], v[180:183], v[64:79]
    s_waitcnt vmcnt(10) lgkmcnt(8)
    v_mfma_f32_32x32x16_bf16 v[16:31], v[88:91], v[184:187], v[16:31]
    v_mfma_f32_32x32x16_bf16 v[48:63], v[92:95], v[184:187], v[48:63]
    v_mfma_f32_32x32x16_bf16 v[32:47], v[88:91], v[188:191], v[32:47]
    v_mfma_f32_32x32x16_bf16 v[64:79], v[92:95], v[188:191], v[64:79]
    s_waitcnt vmcnt(8) lgkmcnt(4)
    v_mfma_f32_32x32x16_bf16 v[16:31], v[96:99], v[192:195], v[16:31]
    v_mfma_f32_32x32x16_bf16 v[48:63], v[100:103], v[192:195], v[48:63]
    v_mfma_f32_32x32x16_bf16 v[32:47], v[96:99], v[196:199], v[32:47]
    v_mfma_f32_32x32x16_bf16 v[64:79], v[100:103], v[196:199], v[64:79]
    s_waitcnt vmcnt(6) lgkmcnt(0)
    v_mfma_f32_32x32x16_bf16 v[16:31], v[104:107], v[200:203], v[16:31]
    v_mfma_f32_32x32x16_bf16 v[48:63], v[108:111], v[200:203], v[48:63]
    v_mfma_f32_32x32x16_bf16 v[32:47], v[104:107], v[204:207], v[32:47]
    v_mfma_f32_32x32x16_bf16 v[64:79], v[108:111], v[204:207], v[64:79]
    s_branch G2J_18
G2B_17:
    s_mov_b64 exec, 0x7f
    s_mov_b32 s59, 32
POLL_21:
    buffer_load_dword v6, v5, s[12:15], s43 offen sc1
    s_sub_u32 s59, s59, 1
    s_cbranch_scc1 POLLB_23
    s_waitcnt vmcnt(0)
    v_cmp_ne_u32 vcc, s56, v6
    s_cmp_eq_u64 vcc, 0
    s_cbranch_scc1 POLLD_22
    s_sleep 4
    s_branch POLL_21
POLLB_23:
    s_waitcnt vmcnt(0)
    s_add_u32 s43, s43, 1933312
    s_mov_b32 exec_lo, 0x7f
    s_mov_b32 exec_hi, 0x0
    s_mov_b32 s59, 4000
POLL_24:
    buffer_load_dword v6, v5, s[12:15], s43 offen sc1
    s_sub_u32 s59, s59, 1
    s_cbranch_scc1 POLLD_25
    s_waitcnt vmcnt(0)
    v_cmp_ne_u32 vcc, s56, v6
    s_cmp_eq_u64 vcc, 0
    s_cbranch_scc1 POLLD_25
    s_sleep 4
    s_branch POLL_24
POLLD_25:
    s_waitcnt vmcnt(0)
    s_mov_b64 exec, -1
POLLD_22:
    s_mov_b64 exec, -1
    s_mov_b32 s62, s42
    buffer_load_dwordx4 v[176:179], v245, s[12:15], s62 offen offset:0 sc1
    buffer_load_dwordx4 v[180:183], v246, s[12:15], s62 offen offset:0 sc1
    buffer_load_dwordx4 v[184:187], v245, s[12:15], s62 offen offset:1024 sc1
    buffer_load_dwordx4 v[188:191], v246, s[12:15], s62 offen offset:1024 sc1
    buffer_load_dwordx4 v[192:195], v245, s[12:15], s62 offen offset:2048 sc1
    buffer_load_dwordx4 v[196:199], v246, s[12:15], s62 offen offset:2048 sc1
    buffer_load_dwordx4 v[200:203], v245, s[12:15], s62 offen offset:3072 sc1
    buffer_load_dwordx4 v[204:207], v246, s[12:15], s62 offen offset:3072 sc1
    s_add_u32 s62, s62, 4096
    s_cmp_eq_u32 s62, 28672
    s_cselect_b32 s62, 0, s62
    buffer_load_dwordx4 v[208:211], v245, s[12:15], s62 offen offset:0 sc1
    buffer_load_dwordx4 v[212:215], v246, s[12:15], s62 offen offset:0 sc1
    buffer_load_dwordx4 v[216:219], v245, s[12:15], s62 offen offset:1024 sc1
    buffer_load_dwordx4 v[220:223], v246, s[12:15], s62 offen offset:1024 sc1
    s_waitcnt vmcnt(10)
    v_mfma_f32_32x32x16_bf16 v[16:31], v[80:83], v[176:179], v[16:31]
    v_mfma_f32_32x32x16_bf16 v[48:63], v[84:87], v[176:179], v[48:63]
    buffer_load_dwordx4 v[176:179], v245, s[12:15], s62 offen offset:2048 sc1
    v_mfma_f32_32x32x16_bf16 v[32:47], v[80:83], v[180:183], v[32:47]
    v_mfma_f32_32x32x16_bf16 v[64:79], v[84:87], v[180:183], v[64:79]
    buffer_load_dwordx4 v[180:183], v246, s[12:15], s62 offen offset:2048 sc1
    s_waitcnt vmcnt(10)
    v_mfma_f32_32x32x16_bf16 v[16:31], v[88:91], v[184:187], v[16:31]
    ds_read_b64_tr_b16 v[80:81], v13 offset:0
    ds_read_b64_tr_b16 v[82:83], v13 offset:1024
    ds_read_b64_tr_b16 v[84:85], v14 offset:0
    ds_read_b64_tr_b16 v[86:87], v14 offset:1024
    v_mfma_f32_32x32x16_bf16 v[48:63], v[92:95], v[184:187], v[48:63]
    buffer_load_dwordx4 v[184:187], v245, s[12:15], s62 offen offset:3072 sc1
    v_mfma_f32_32x32x16_bf16 v[32:47], v[88:91], v[188:191], v[32:47]
    v_mfma_f32_32x32x16_bf16 v[64:79], v[92:95], v[188:191], v[64:79]
    buffer_load_dwordx4 v[188:191], v246, s[12:15], s62 offen offset:3072 sc1
    s_waitcnt vmcnt(10)
    v_mfma_f32_32x32x16_bf16 v[16:31], v[96:99], v[192:195], v[16:31]
    ds_read_b64_tr_b16 v[88:89], v11 offset:32768
    ds_read_b64_tr_b16 v[90:91], v11 offset:33792
    ds_read_b64_tr_b16 v[92:93], v12 offset:32768
    ds_read_b64_tr_b16 v[94:95], v12 offset:33792
    v_mfma_f32_32x32x16_bf16 v[48:63], v[100:103], v[192:195], v[48:63]
    s_add_u32 s62, s62, 4096
    s_cmp_eq_u32 s62, 28672
    s_cselect_b32 s62, 0, s62
    buffer_load_dwordx4 v[192:195], v245, s[12:15], s62 offen offset:0 sc1
    v_mfma_f32_32x32x16_bf16 v[32:47], v[96:99], v[196:199], v[32:47]
    s_waitcnt lgkmcnt(4)
    s_add_u32 m0, s39, 65536
    s_nop 0
    buffer_load_dwordx4 v250, s[20:23], s40 offen lds
    buffer_load_dwordx4 v251, s[20:23], s40 offen offset:1024 lds
    s_add_u32 s40, s40, 14336
    s_cmp_eq_u32 s40, s41
    s_cselect_b32 s40, s38, s40
    v_mfma_f32_32x32x16_bf16 v[64:79], v[100:103], v[196:199], v[64:79]
    buffer_load_dwordx4 v[196:199], v246, s[12:15], s62 offen offset:0 sc1
    s_waitcnt vmcnt(12)
    v_mfma_f32_32x32x16_bf16 v[16:31], v[104:107], v[200:203], v[16:31]
    ds_read_b64_tr_b16 v[96:97], v11 offset:40960
    ds_read_b64_tr_b16 v[98:99], v11 offset:41984
    ds_read_b64_tr_b16 v[100:101], v12 offset:40960
    ds_read_b64_tr_b16 v[102:103], v12 offset:41984
    v_mfma_f32_32x32x16_bf16 v[48:63], v[108:111], v[200:203], v[48:63]
    buffer_load_dwordx4 v[200:203], v245, s[12:15], s62 offen offset:1024 sc1
    v_mfma_f32_32x32x16_bf16 v[32:47], v[104:107], v[204:207], v[32:47]
    s_waitcnt lgkmcnt(4)
    s_add_u32 m0, s39, 32768
    s_nop 0
    buffer_load_dwordx4 v250, s[20:23], s40 offen lds
    buffer_load_dwordx4 v251, s[20:23], s40 offen offset:1024 lds
    s_add_u32 s40, s40, 14336
    s_cmp_eq_u32 s40, s41
    s_cselect_b32 s40, s38, s40
    v_mfma_f32_32x32x16_bf16 v[64:79], v[108:111], v[204:207], v[64:79]
    buffer_load_dwordx4 v[204:207], v246, s[12:15], s62 offen offset:1024 sc1
    s_waitcnt vmcnt(14)
    v_mfma_f32_32x32x16_bf16 v[16:31], v[112:115], v[208:211], v[16:31]
    ds_read_b64_tr_b16 v[104:105], v13 offset:8192
    ds_read_b64_tr_b16 v[106:107], v13 offset:9216
    ds_read_b64_tr_b16 v[108:109], v14 offset:8192
    ds_read_b64_tr_b16 v[110:111], v14 offset:9216
    v_mfma_f32_32x32x16_bf16 v[48:63], v[116:119], v[208:211], v[48:63]
    buffer_load_dwordx4 v[208:211], v245, s[12:15], s62 offen offset:2048 sc1
    v_mfma_f32_32x32x16_bf16 v[32:47], v[112:115], v[212:215], v[32:47]
    s_waitcnt lgkmcnt(4)
    s_add_u32 m0, s39, 40960
    s_nop 0
    buffer_load_dwordx4 v250, s[20:23], s40 offen lds
    buffer_load_dwordx4 v251, s[20:23], s40 offen offset:1024 lds
    s_add_u32 s40, s40, 14336
    s_cmp_eq_u32 s40, s41
    s_cselect_b32 s40, s38, s40
    v_mfma_f32_32x32x16_bf16 v[64:79], v[116:119], v[212:215], v[64:79]
    buffer_load_dwordx4 v[212:215], v246, s[12:15], s62 offen offset:2048 sc1
    s_waitcnt vmcnt(16)
    v_mfma_f32_32x32x16_bf16 v[16:31], v[120:123], v[216:219], v[16:31]
    ds_read_b64_tr_b16 v[112:113], v11 offset:49152
    ds_read_b64_tr_b16 v[114:115], v11 offset:50176
    ds_read_b64_tr_b16 v[116:117], v12 offset:49152
    ds_read_b64_tr_b16 v[118:119], v12 offset:50176
    v_mfma_f32_32x32x16_bf16 v[48:63], v[124:127], v[216:219], v[48:63]
    buffer_load_dwordx4 v[216:219], v245, s[12:15], s62 offen offset:3072 sc1
    v_mfma_f32_32x32x16_bf16 v[32:47], v[120:123], v[220:223], v[32:47]
    s_waitcnt lgkmcnt(4)
    s_add_u32 m0, s39, 73728
    s_nop 0
    buffer_load_dwordx4 v250, s[20:23], s40 offen lds
    buffer_load_dwordx4 v251, s[20:23], s40 offen offset:1024 lds
    s_add_u32 s40, s40, 14336
    s_cmp_eq_u32 s40, s41
    s_cselect_b32 s40, s38, s40
    v_mfma_f32_32x32x16_bf16 v[64:79], v[124:127], v[220:223], v[64:79]
    buffer_load_dwordx4 v[220:223], v246, s[12:15], s62 offen offset:3072 sc1
    s_waitcnt vmcnt(18)
    v_mfma_f32_32x32x16_bf16 v[16:31], v[128:131], v[176:179], v[16:31]
    ds_read_b64_tr_b16 v[120:121], v11 offset:0
    ds_read_b64_tr_b16 v[122:123], v11 offset:1024
    ds_read_b64_tr_b16 v[124:125], v12 offset:0
    ds_read_b64_tr_b16 v[126:127], v12 offset:1024
    v_mfma_f32_32x32x16_bf16 v[48:63], v[132:135], v[176:179], v[48:63]
    s_add_u32 s62, s62, 4096
    s_cmp_eq_u32 s62, 28672
    s_cselect_b32 s62, 0, s62
    buffer_load_dwordx4 v[176:179], v245, s[12:15], s62 offen offset:0 sc1
    v_mfma_f32_32x32x16_bf16 v[32:47], v[128:131], v[180:183], v[32:47]
    s_waitcnt lgkmcnt(4)
    s_add_u32 m0, s39, 49152
    s_nop 0
    buffer_load_dwordx4 v250, s[20:23], s40 offen lds
    buffer_load_dwordx4 v251, s[20:23], s40 offen offset:1024 lds
    s_add_u32 s40, s40, 14336
    s_cmp_eq_u32 s40, s41
    s_cselect_b32 s40, s38, s40
    v_mfma_f32_32x32x16_bf16 v[64:79], v[132:135], v[180:183], v[64:79]
    buffer_load_dwordx4 v[180:183], v246, s[12:15], s62 offen offset:0 sc1
    s_waitcnt vmcnt(20)
    v_mfma_f32_32x32x16_bf16 v[16:31], v[136:139], v[184:187], v[16:31]
    ds_read_b64_tr_b16 v[128:129], v11 offset:8192
    ds_read_b64_tr_b16 v[130:131], v11 offset:9216
    ds_read_b64_tr_b16 v[132:133], v12 offset:8192
    ds_read_b64_tr_b16 v[134:135], v12 offset:9216
    v_mfma_f32_32x32x16_bf16 v[48:63], v[140:143], v[184:187], v[48:63]
    buffer_load_dwordx4 v[184:187], v245, s[12:15], s62 offen offset:1024 sc1
    v_mfma_f32_32x32x16_bf16 v[32:47], v[136:139], v[188:191], v[32:47]
    s_waitcnt lgkmcnt(4)
    s_mov_b32 m0, s39
    s_nop 0
    buffer_load_dwordx4 v250, s[20:23], s40 offen lds
    buffer_load_dwordx4 v251, s[20:23], s40 offen offset:1024 lds
    s_add_u32 s40, s40, 14336
    s_cmp_eq_u32 s40, s41
    s_cselect_b32 s40, s38, s40
    v_mfma_f32_32x32x16_bf16 v[64:79], v[140:143], v[188:191], v[64:79]
    buffer_load_dwordx4 v[188:191], v246, s[12:15], s62 offen offset:1024 sc1
    s_waitcnt vmcnt(20)
    v_mfma_f32_32x32x16_bf16 v[16:31], v[144:147], v[192:195], v[16:31]
    ds_read_b64_tr_b16 v[136:137], v11 offset:57344
    ds_read_b64_tr_b16 v[138:139], v11 offset:58368
    ds_read_b64_tr_b16 v[140:141], v12 offset:57344
    ds_read_b64_tr_b16 v[142:143], v12 offset:58368
    v_mfma_f32_32x32x16_bf16 v[48:63], v[148:151], v[192:195], v[48:63]
    buffer_load_dwordx4 v[192:195], v245, s[12:15], s62 offen offset:2048 sc1
    v_mfma_f32_32x32x16_bf16 v[32:47], v[144:147], v[196:199], v[32:47]
    v_mfma_f32_32x32x16_bf16 v[64:79], v[148:151], v[196:199], v[64:79]
    buffer_load_dwordx4 v[196:199], v246, s[12:15], s62 offen offset:2048 sc1
    s_waitcnt vmcnt(18)
    v_mfma_f32_32x32x16_bf16 v[16:31], v[152:155], v[200:203], v[16:31]
    ds_read_b64_tr_b16 v[144:145], v11 offset:16384
    ds_read_b64_tr_b16 v[146:147], v11 offset:17408
    ds_read_b64_tr_b16 v[148:149], v12 offset:16384
    ds_read_b64_tr_b16 v[150:151], v12 offset:17408
    v_mfma_f32_32x32x16_bf16 v[48:63], v[156:159], v[200:203], v[48:63]
    buffer_load_dwordx4 v[200:203], v245, s[12:15], s62 offen offset:3072 sc1
    v_mfma_f32_32x32x16_bf16 v[32:47], v[152:155], v[204:207], v[32:47]
    v_mfma_f32_32x32x16_bf16 v[64:79], v[156:159], v[204:207], v[64:79]
    buffer_load_dwordx4 v[204:207], v246, s[12:15], s62 offen offset:3072 sc1
    s_waitcnt vmcnt(16)
    v_mfma_f32_32x32x16_bf16 v[16:31], v[160:163], v[208:211], v[16:31]
    ds_read_b64_tr_b16 v[152:153], v11 offset:24576
    ds_read_b64_tr_b16 v[154:155], v11 offset:25600
    ds_read_b64_tr_b16 v[156:157], v12 offset:24576
    ds_read_b64_tr_b16 v[158:159], v12 offset:25600
    v_mfma_f32_32x32x16_bf16 v[48:63], v[164:167], v[208:211], v[48:63]
    s_add_u32 s62, s62, 4096
    s_cmp_eq_u32 s62, 28672
    s_cselect_b32 s62, 0, s62
    buffer_load_dwordx4 v[208:211], v245, s[12:15], s62 offen offset:0 sc1
    v_mfma_f32_32x32x16_bf16 v[32:47], v[160:163], v[212:215], v[32:47]
    v_mfma_f32_32x32x16_bf16 v[64:79], v[164:167], v[212:215], v[64:79]
    buffer_load_dwordx4 v[212:215], v246, s[12:15], s62 offen offset:0 sc1
    s_waitcnt vmcnt(14)
    v_mfma_f32_32x32x16_bf16 v[16:31], v[168:171], v[216:219], v[16:31]
    ds_read_b64_tr_b16 v[160:161], v13 offset:0
    ds_read_b64_tr_b16 v[162:163], v13 offset:1024
    ds_read_b64_tr_b16 v[164:165], v14 offset:0
    ds_read_b64_tr_b16 v[166:167], v14 offset:1024
    v_mfma_f32_32x32x16_bf16 v[48:63], v[172:175], v[216:219], v[48:63]
    buffer_load_dwordx4 v[216:219], v245, s[12:15], s62 offen offset:1024 sc1
    v_mfma_f32_32x32x16_bf16 v[32:47], v[168:171], v[220:223], v[32:47]
    v_mfma_f32_32x32x16_bf16 v[64:79], v[172:175], v[220:223], v[64:79]
    buffer_load_dwordx4 v[220:223], v246, s[12:15], s62 offen offset:1024 sc1
    s_waitcnt vmcnt(12)
    v_mfma_f32_32x32x16_bf16 v[16:31], v[80:83], v[176:179], v[16:31]
    ds_read_b64_tr_b16 v[168:169], v11 offset:32768
    ds_read_b64_tr_b16 v[170:171], v11 offset:33792
    ds_read_b64_tr_b16 v[172:173], v12 offset:32768
    ds_read_b64_tr_b16 v[174:175], v12 offset:33792
    v_mfma_f32_32x32x16_bf16 v[48:63], v[84:87], v[176:179], v[48:63]
    buffer_load_dwordx4 v[176:179], v245, s[12:15], s62 offen offset:2048 sc1
    v_mfma_f32_32x32x16_bf16 v[32:47], v[80:83], v[180:183], v[32:47]
    v_mfma_f32_32x32x16_bf16 v[64:79], v[84:87], v[180:183], v[64:79]
    buffer_load_dwordx4 v[180:183], v246, s[12:15], s62 offen offset:2048 sc1
    s_waitcnt vmcnt(10)
    v_mfma_f32_32x32x16_bf16 v[16:31], v[88:91], v[184:187], v[16:31]
    ds_read_b64_tr_b16 v[80:81], v11 offset:40960
    ds_read_b64_tr_b16 v[82:83], v11 offset:41984
    ds_read_b64_tr_b16 v[84:85], v12 offset:40960
    ds_read_b64_tr_b16 v[86:87], v12 offset:41984
    v_mfma_f32_32x32x16_bf16 v[48:63], v[92:95], v[184:187], v[48:63]
    buffer_load_dwordx4 v[184:187], v245, s[12:15], s62 offen offset:3072 sc1
    v_mfma_f32_32x32x16_bf16 v[32:47], v[88:91], v[188:191], v[32:47]
    v_mfma_f32_32x32x16_bf16 v[64:79], v[92:95], v[188:191], v[64:79]
    buffer_load_dwordx4 v[188:191], v246, s[12:15], s62 offen offset:3072 sc1
    s_waitcnt vmcnt(10)
    v_mfma_f32_32x32x16_bf16 v[16:31], v[96:99], v[192:195], v[16:31]
    ds_read_b64_tr_b16 v[88:89], v13 offset:8192
    ds_read_b64_tr_b16 v[90:91], v13 offset:9216
    ds_read_b64_tr_b16 v[92:93], v14 offset:8192
    ds_read_b64_tr_b16 v[94:95], v14 offset:9216
    v_mfma_f32_32x32x16_bf16 v[48:63], v[100:103], v[192:195], v[48:63]
    s_add_u32 s62, s62, 4096
    s_cmp_eq_u32 s62, 28672
    s_cselect_b32 s62, 0, s62
    buffer_load_dwordx4 v[192:195], v245, s[12:15], s62 offen offset:0 sc1
    v_mfma_f32_32x32x16_bf16 v[32:47], v[96:99], v[196:199], v[32:47]
    v_mfma_f32_32x32x16_bf16 v[64:79], v[100:103], v[196:199], v[64:79]
    buffer_load_dwordx4 v[196:199], v246, s[12:15], s62 offen offset:0 sc1
    s_waitcnt vmcnt(10)
    v_mfma_f32_32x32x16_bf16 v[16:31], v[104:107], v[200:203], v[16:31]
    ds_read_b64_tr_b16 v[96:97], v11 offset:49152
    ds_read_b64_tr_b16 v[98:99], v11 offset:50176
    ds_read_b64_tr_b16 v[100:101], v12 offset:49152
    ds_read_b64_tr_b16 v[102:103], v12 offset:50176
    v_mfma_f32_32x32x16_bf16 v[48:63], v[108:111], v[200:203], v[48:63]
    buffer_load_dwordx4 v[200:203], v245, s[12:15], s62 offen offset:1024 sc1
    v_mfma_f32_32x32x16_bf16 v[32:47], v[104:107], v[204:207], v[32:47]
    v_mfma_f32_32x32x16_bf16 v[64:79], v[108:111], v[204:207], v[64:79]
    buffer_load_dwordx4 v[204:207], v246, s[12:15], s62 offen offset:1024 sc1
    s_waitcnt vmcnt(10)
    v_mfma_f32_32x32x16_bf16 v[16:31], v[112:115], v[208:211], v[16:31]
    ds_read_b64_tr_b16 v[104:105], v11 offset:0
    ds_read_b64_tr_b16 v[106:107], v11 offset:1024
    ds_read_b64_tr_b16 v[108:109], v12 offset:0
    ds_read_b64_tr_b16 v[110:111], v12 offset:1024
    v_mfma_f32_32x32x16_bf16 v[48:63], v[116:119], v[208:211], v[48:63]
    buffer_load_dwordx4 v[208:211], v245, s[12:15], s62 offen offset:2048 sc1
    v_mfma_f32_32x32x16_bf16 v[32:47], v[112:115], v[212:215], v[32:47]
    v_mfma_f32_32x32x16_bf16 v[64:79], v[116:119], v[212:215], v[64:79]
    buffer_load_dwordx4 v[212:215], v246, s[12:15], s62 offen offset:2048 sc1
    v_and_b32 v5, 63, v0
    v_lshlrev_b32 v5, 2, v5
    s_lshl_b32 s45, s37, 1
    s_lshr_b32 s46, s61, 4
    s_add_u32 s45, s45, s46
    s_mul_i32 s45, s45, 2304
    s_lshl_b32 s46, s32, 6
    s_add_u32 s45, s45, s46
    s_add_u32 s45, s45, 2048000
    s_mov_b64 exec, 0xffff
    buffer_load_dword v6, v5, s[12:15], s45 offen sc1
    s_mov_b64 exec, -1
    s_waitcnt vmcnt(11)
    v_mfma_f32_32x32x16_bf16 v[16:31], v[120:123], v[216:219], v[16:31]
    v_mfma_f32_32x32x16_bf16 v[48:63], v[124:127], v[216:219], v[48:63]
    buffer_load_dwordx4 v[216:219], v245, s[12:15], s62 offen offset:3072 sc1
    v_mfma_f32_32x32x16_bf16 v[32:47], v[120:123], v[220:223], v[32:47]
    v_mfma_f32_32x32x16_bf16 v[64:79], v[124:127], v[220:223], v[64:79]
    buffer_load_dwordx4 v[220:223], v246, s[12:15], s62 offen offset:3072 sc1
    s_waitcnt vmcnt(11) lgkmcnt(15)
    v_mfma_f32_32x32x16_bf16 v[16:31], v[128:131], v[176:179], v[16:31]
    v_mfma_f32_32x32x16_bf16 v[48:63], v[132:135], v[176:179], v[48:63]
    s_add_u32 s62, s62, 4096
    s_cmp_eq_u32 s62, 28672
    s_cselect_b32 s62, 0, s62
    buffer_load_dwordx4 v[176:179], v245, s[12:15], s62 offen offset:0 sc1
    v_mfma_f32_32x32x16_bf16 v[32:47], v[128:131], v[180:183], v[32:47]
    v_mfma_f32_32x32x16_bf16 v[64:79], v[132:135], v[180:183], v[64:79]
    buffer_load_dwordx4 v[180:183], v246, s[12:15], s62 offen offset:0 sc1
    s_waitcnt vmcnt(11)
    v_mfma_f32_32x32x16_bf16 v[16:31], v[136:139], v[184:187], v[16:31]
    v_mfma_f32_32x32x16_bf16 v[48:63], v[140:143], v[184:187], v[48:63]
    buffer_load_dwordx4 v[184:187], v245, s[12:15], s62 offen offset:1024 sc1
    v_mfma_f32_32x32x16_bf16 v[32:47], v[136:139], v[188:191], v[32:47]
    v_mfma_f32_32x32x16_bf16 v[64:79], v[140:143], v[188:191], v[64:79]
    buffer_load_dwordx4 v[188:191], v246, s[12:15], s62 offen offset:1024 sc1
    s_waitcnt vmcnt(11)
    v_mfma_f32_32x32x16_bf16 v[16:31], v[144:147], v[192:195], v[16:31]
    v_mfma_f32_32x32x16_bf16 v[48:63], v[148:151], v[192:195], v[48:63]
    buffer_load_dwordx4 v[192:195], v245, s[12:15], s62 offen offset:2048 sc1
    v_mfma_f32_32x32x16_bf16 v[32:47], v[144:147], v[196:199], v[32:47]
    v_mfma_f32_32x32x16_bf16 v[64:79], v[148:151], v[196:199], v[64:79]
    buffer_load_dwordx4 v[196:199], v246, s[12:15], s62 offen offset:2048 sc1
    s_waitcnt vmcnt(11)
    v_mfma_f32_32x32x16_bf16 v[16:31], v[152:155], v[200:203], v[16:31]
    v_mfma_f32_32x32x16_bf16 v[48:63], v[156:159], v[200:203], v[48:63]
    buffer_load_dwordx4 v[200:203], v245, s[12:15], s62 offen offset:3072 sc1
    v_mfma_f32_32x32x16_bf16 v[32:47], v[152:155], v[204:207], v[32:47]
    v_mfma_f32_32x32x16_bf16 v[64:79], v[156:159], v[204:207], v[64:79]
    buffer_load_dwordx4 v[204:207], v246, s[12:15], s62 offen offset:3072 sc1
    s_lshl_b32 s45, s37, 7
    s_lshr_b32 s46, s32, 1
    s_lshl_b32 s46, s46, 6
    s_add_u32 s45, s45, s46
    buffer_load_dwordx4 v[228:231], v224, s[4:7], s60 offen
    buffer_load_dwordx4 v[232:235], v224, s[4:7], s60 offen offset:32
    buffer_load_dwordx4 v[236:239], v244, s[28:31], s45 offen
    buffer_load_dwordx4 v[240:243], v244, s[28:31], s45 offen offset:32
    s_waitcnt vmcnt(15)
    v_mfma_f32_32x32x16_bf16 v[16:31], v[160:163], v[208:211], v[16:31]
    v_mfma_f32_32x32x16_bf16 v[48:63], v[164:167], v[208:211], v[48:63]
    v_mfma_f32_32x32x16_bf16 v[32:47], v[160:163], v[212:215], v[32:47]
    v_mfma_f32_32x32x16_bf16 v[64:79], v[164:167], v[212:215], v[64:79]
    s_waitcnt vmcnt(14)
    s_mov_b64 exec, 0xffff
    v_cmp_ne_u32 vcc, s56, v6
    s_mov_b64 exec, -1
    s_cmp_eq_u64 vcc, 0
    s_cselect_b32 s44, 1, 0
    s_lshl_b32 s45, s37, 2
    s_add_u32 s45, s45, s32
    s_lshl_b32 s45, s45, 16
    s_lshl_b32 s46, s61, 7
    s_add_u32 s45, s45, s46
    s_add_u32 s45, s45, 4194304
    s_add_u32 s46, s45, 32768
    s_cmp_eq_u32 s44, 0
    s_cbranch_scc1 G2S0_26
    s_add_u32 m0, s39, 65536
    s_nop 0
    buffer_load_dwordx4 v254, s[12:15], s45 offen sc1 lds
    s_add_u32 m0, s39, 66560
    s_nop 0
    buffer_load_dwordx4 v255, s[12:15], s46 offen sc1 lds
    s_branch G2S1_27
G2S0_26:
    buffer_load_dword v6, v5, s[12:15], s45 offen
    buffer_load_dword v6, v5, s[12:15], s45 offen
G2S1_27:
    s_waitcnt vmcnt(14)
    v_mfma_f32_32x32x16_bf16 v[16:31], v[168:171], v[216:219], v[16:31]
    v_mfma_f32_32x32x16_bf16 v[48:63], v[172:175], v[216:219], v[48:63]
    v_mfma_f32_32x32x16_bf16 v[32:47], v[168:171], v[220:223], v[32:47]
    v_mfma_f32_32x32x16_bf16 v[64:79], v[172:175], v[220:223], v[64:79]
    s_waitcnt vmcnt(12) lgkmcnt(12)
    v_mfma_f32_32x32x16_bf16 v[16:31], v[80:83], v[176:179], v[16:31]
    v_mfma_f32_32x32x16_bf16 v[48:63], v[84:87], v[176:179], v[48:63]
    v_mfma_f32_32x32x16_bf16 v[32:47], v[80:83], v[180:183], v[32:47]
    v_mfma_f32_32x32x16_bf16 v[64:79], v[84:87], v[180:183], v[64:79]
    s_waitcnt vmcnt(10) lgkmcnt(8)
    v_mfma_f32_32x32x16_bf16 v[16:31], v[88:91], v[184:187], v[16:31]
    v_mfma_f32_32x32x16_bf16 v[48:63], v[92:95], v[184:187], v[48:63]
    v_mfma_f32_32x32x16_bf16 v[32:47], v[88:91], v[188:191], v[32:47]
    v_mfma_f32_32x32x16_bf16 v[64:79], v[92:95], v[188:191], v[64:79]
    s_waitcnt vmcnt(8) lgkmcnt(4)
    v_mfma_f32_32x32x16_bf16 v[16:31], v[96:99], v[192:195], v[16:31]
    v_mfma_f32_32x32x16_bf16 v[48:63], v[100:103], v[192:195], v[48:63]
    v_mfma_f32_32x32x16_bf16 v[32:47], v[96:99], v[196:199], v[32:47]
    v_mfma_f32_32x32x16_bf16 v[64:79], v[100:103], v[196:199], v[64:79]
    s_waitcnt vmcnt(6) lgkmcnt(0)
    v_mfma_f32_32x32x16_bf16 v[16:31], v[104:107], v[200:203], v[16:31]
    v_mfma_f32_32x32x16_bf16 v[48:63], v[108:111], v[200:203], v[48:63]
    v_mfma_f32_32x32x16_bf16 v[32:47], v[104:107], v[204:207], v[32:47]
    v_mfma_f32_32x32x16_bf16 v[64:79], v[108:111], v[204:207], v[64:79]
G2J_18:
    s_cmp_lg_u32 s44, 0
    s_cbranch_scc1 G2SE_28
    v_and_b32 v247, 63, v0
    v_lshlrev_b32 v247, 2, v247
    s_lshl_b32 s45, s37, 1
    s_lshr_b32 s46, s61, 4
    s_add_u32 s45, s45, s46
    s_mul_i32 s45, s45, 2304
    s_lshl_b32 s46, s32, 6
    s_add_u32 s45, s45, s46
    s_add_u32 s45, s45, 2048000
    s_mov_b32 exec_lo, 0xffff
    s_mov_b32 exec_hi, 0x0
    s_mov_b32 s59, 4000
POLL_29:
    buffer_load_dword v248, v247, s[12:15], s45 offen sc1
    s_sub_u32 s59, s59, 1
    s_cbranch_scc1 POLLD_30
    s_waitcnt vmcnt(0)
    v_cmp_ne_u32 vcc, s56, v248
    s_cmp_eq_u64 vcc, 0
    s_cbranch_scc1 POLLD_30
    s_sleep 4
    s_branch POLL_29
POLLD_30:
    s_waitcnt vmcnt(0)
    s_mov_b64 exec, -1
    s_lshl_b32 s45, s37, 2
    s_add_u32 s45, s45, s32
    s_lshl_b32 s45, s45, 16
    s_lshl_b32 s46, s61, 7
    s_add_u32 s45, s45, s46
    s_add_u32 s45, s45, 4194304
    s_add_u32 s46, s45, 32768
    s_add_u32 m0, s39, 65536
    s_nop 0
    buffer_load_dwordx4 v254, s[12:15], s45 offen sc1 lds
    s_add_u32 m0, s39, 66560
    s_nop 0
    buffer_load_dwordx4 v255, s[12:15], s46 offen sc1 lds
G2SE_28:
    v_lshlrev_b32 v84, 4, v1
    v_add_u32 v80, s39, v84
    s_xor_b32 s45, s32, 1
    s_lshl_b32 s45, s45, 11
    v_add_u32 v81, s45, v84
    s_xor_b32 s45, s32, 2
    s_lshl_b32 s45, s45, 11
    v_add_u32 v82, s45, v84
    s_xor_b32 s45, s32, 3
    s_lshl_b32 s45, s45, 11
    v_add_u32 v83, s45, v84
    ds_write_b128 v80, v[48:51] offset:16384
    ds_write_b128 v80, v[52:55] offset:17408
    ds_write_b128 v80, v[56:59] offset:24576
    ds_write_b128 v80, v[60:63] offset:25600
    ds_write_b128 v80, v[32:35] offset:0
    ds_write_b128 v80, v[36:39] offset:1024
    ds_write_b128 v80, v[40:43] offset:8192
    ds_write_b128 v80, v[44:47] offset:9216
    ds_write_b128 v80, v[64:67] offset:32768
    ds_write_b128 v80, v[68:71] offset:33792
    ds_write_b128 v80, v[72:75] offset:40960
    ds_write_b128 v80, v[76:79] offset:41984
    v_lshl_add_u32 v84, v10, 2, v8
    v_lshlrev_b32 v84, 7, v84
    v_bfe_u32 v2, v1, 4, 1
    v_lshlrev_b32 v2, 1, v2
    v_lshrrev_b32 v3, 1, v9
    v_or_b32 v2, v2, v3
    v_lshrrev_b32 v3, 1, v8
    v_xor_b32 v2, v2, v3
    s_and_b32 s45, s32, 1
    s_lshl_b32 s45, s45, 2
    v_xor_b32 v2, s45, v2
    v_lshl_add_u32 v84, v2, 4, v84
    v_and_b32 v2, 1, v9
    v_lshl_add_u32 v84, v2, 3, v84
    s_lshr_b32 s45, s32, 1
    s_lshl_b32 s45, s45, 12
    s_add_u32 s45, s45, 0x10000
    v_add_u32 v84, s45, v84
    v_xor_b32 v85, 32, v84
    v_xor_b32 v86, 64, v84
    v_xor_b32 v87, 96, v84
    v_and_b32 v2, 15, v1
    v_mul_u32_u24 v88, 896, v2
    v_bfe_u32 v2, v1, 4, 1
    v_lshl_add_u32 v88, v2, 5, v88
    v_lshl_add_u32 v88, v10, 4, v88
    s_add_u32 s46, s60, 14336
    s_waitcnt vmcnt(0)
    v_permlane32_swap_b32 v228, v230
    v_permlane32_swap_b32 v229, v231
    v_permlane32_swap_b32 v232, v234
    v_permlane32_swap_b32 v233, v235
    v_permlane32_swap_b32 v236, v238
    v_permlane32_swap_b32 v237, v239
    v_permlane32_swap_b32 v240, v242
    v_permlane32_swap_b32 v241, v243
    v_lshlrev_b32 v120, 16, v236
    v_and_b32 v121, 0xffff0000, v236
    v_lshlrev_b32 v122, 16, v237
    v_and_b32 v123, 0xffff0000, v237
    v_lshlrev_b32 v124, 16, v238
    v_and_b32 v125, 0xffff0000, v238
    v_lshlrev_b32 v126, 16, v239
    v_and_b32 v127, 0xffff0000, v239
    v_lshlrev_b32 v128, 16, v240
    v_and_b32 v129, 0xffff0000, v240
    v_lshlrev_b32 v130, 16, v241
    v_and_b32 v131, 0xffff0000, v241
    v_lshlrev_b32 v132, 16, v242
    v_and_b32 v133, 0xffff0000, v242
    v_lshlrev_b32 v134, 16, v243
    v_and_b32 v135, 0xffff0000, v243
    v_lshlrev_b32 v136, 16, v228
    v_and_b32 v137, 0xffff0000, v228
    v_lshlrev_b32 v138, 16, v229
    v_and_b32 v139, 0xffff0000, v229
    v_lshlrev_b32 v140, 16, v230
    v_and_b32 v141, 0xffff0000, v230
    v_lshlrev_b32 v142, 16, v231
    v_and_b32 v143, 0xffff0000, v231
    v_lshlrev_b32 v144, 16, v232
    v_and_b32 v145, 0xffff0000, v232
    v_lshlrev_b32 v146, 16, v233
    v_and_b32 v147, 0xffff0000, v233
    v_lshlrev_b32 v148, 16, v234
    v_and_b32 v149, 0xffff0000, v234
    v_lshlrev_b32 v150, 16, v235
    v_and_b32 v151, 0xffff0000, v235
    v_mov_b32 v184, 0xbfb8aa3b
    v_mov_b32 v186, 1.0
    v_pk_add_f32 v[16:17], v[16:17], v[120:121]
    v_pk_add_f32 v[18:19], v[18:19], v[122:123]
    v_pk_add_f32 v[20:21], v[20:21], v[124:125]
    v_pk_add_f32 v[22:23], v[22:23], v[126:127]
    v_pk_add_f32 v[24:25], v[24:25], v[128:129]
    v_pk_add_f32 v[26:27], v[26:27], v[130:131]
    v_pk_add_f32 v[28:29], v[28:29], v[132:133]
    v_pk_add_f32 v[30:31], v[30:31], v[134:135]
    s_waitcnt vmcnt(0) lgkmcnt(0)
    s_barrier
    ds_read_b128 v[32:35], v81 offset:0
    ds_read_b128 v[48:51], v82 offset:16384
    ds_read_b128 v[64:67], v83 offset:32768
    ds_read_b64_tr_b16 v[160:161], v84 offset:0
    ds_read_b64_tr_b16 v[162:163], v85 offset:1024
    ds_read_b128 v[36:39], v81 offset:1024
    ds_read_b128 v[52:55], v82 offset:17408
    ds_read_b128 v[68:71], v83 offset:33792
    ds_read_b64_tr_b16 v[164:165], v86 offset:2048
    ds_read_b64_tr_b16 v[166:167], v87 offset:3072
    ds_read_b128 v[40:43], v81 offset:8192
    ds_read_b128 v[56:59], v82 offset:24576
    ds_read_b128 v[72:75], v83 offset:40960
    ds_read_b128 v[44:47], v81 offset:9216
    ds_read_b128 v[60:63], v82 offset:25600
    ds_read_b128 v[76:79], v83 offset:41984
    s_waitcnt lgkmcnt(13)
    v_pk_add_f32 v[32:33], v[32:33], v[48:49]
    v_pk_add_f32 v[16:17], v[16:17], v[64:65]
    v_pk_add_f32 v[34:35], v[34:35], v[50:51]
    v_pk_add_f32 v[18:19], v[18:19], v[66:67]
    v_pk_add_f32 v[16:17], v[16:17], v[32:33]
    v_pk_add_f32 v[18:19], v[18:19], v[34:35]
    v_pk_mul_f32 v[32:33], v[16:17], v[184:185] op_sel:[0,0] op_sel_hi:[1,0]
    v_pk_mul_f32 v[34:35], v[18:19], v[184:185] op_sel:[0,0] op_sel_hi:[1,0]
    v_exp_f32 v32, v32
    v_exp_f32 v33, v33
    v_exp_f32 v34, v34
    v_exp_f32 v35, v35
    s_waitcnt lgkmcnt(12)
    v_lshlrev_b32 v168, 16, v160
    v_and_b32 v169, 0xffff0000, v160
    v_lshlrev_b32 v170, 16, v161
    v_and_b32 v171, 0xffff0000, v161
    v_pk_add_f32 v[32:33], v[32:33], v[186:187] op_sel_hi:[1,0]
    v_pk_add_f32 v[34:35], v[34:35], v[186:187] op_sel_hi:[1,0]
    v_rcp_f32 v32, v32
    v_rcp_f32 v33, v33
    v_rcp_f32 v34, v34
    v_rcp_f32 v35, v35
    v_pk_mul_f32 v[16:17], v[16:17], v[32:33]
    v_pk_mul_f32 v[18:19], v[18:19], v[34:35]
    v_pk_fma_f32 v[16:17], v[16:17], v[168:169], v[136:137]
    v_pk_fma_f32 v[18:19], v[18:19], v[170:171], v[138:139]
    v_cvt_pk_bf16_f32 v208, v16, v17
    v_cvt_pk_bf16_f32 v209, v18, v19
    s_waitcnt lgkmcnt(8)
    v_pk_add_f32 v[36:37], v[36:37], v[52:53]
    v_pk_add_f32 v[20:21], v[20:21], v[68:69]
    v_pk_add_f32 v[38:39], v[38:39], v[54:55]
    v_pk_add_f32 v[22:23], v[22:23], v[70:71]
    v_pk_add_f32 v[20:21], v[20:21], v[36:37]
    v_pk_add_f32 v[22:23], v[22:23], v[38:39]
    v_pk_mul_f32 v[36:37], v[20:21], v[184:185] op_sel:[0,0] op_sel_hi:[1,0]
    v_pk_mul_f32 v[38:39], v[22:23], v[184:185] op_sel:[0,0] op_sel_hi:[1,0]
    v_exp_f32 v36, v36
    v_exp_f32 v37, v37
    v_exp_f32 v38, v38
    v_exp_f32 v39, v39
    v_lshlrev_b32 v172, 16, v162
    v_and_b32 v173, 0xffff0000, v162
    v_lshlrev_b32 v174, 16, v163
    v_and_b32 v175, 0xffff0000, v163
    v_pk_add_f32 v[36:37], v[36:37], v[186:187] op_sel_hi:[1,0]
    v_pk_add_f32 v[38:39], v[38:39], v[186:187] op_sel_hi:[1,0]
    v_rcp_f32 v36, v36
    v_rcp_f32 v37, v37
    v_rcp_f32 v38, v38
    v_rcp_f32 v39, v39
    v_pk_mul_f32 v[20:21], v[20:21], v[36:37]
    v_pk_mul_f32 v[22:23], v[22:23], v[38:39]
    v_pk_fma_f32 v[20:21], v[20:21], v[172:173], v[140:141]
    v_pk_fma_f32 v[22:23], v[22:23], v[174:175], v[142:143]
    v_cvt_pk_bf16_f32 v210, v20, v21
    v_cvt_pk_bf16_f32 v211, v22, v23
    s_nop 1
    v_permlane32_swap_b32 v208, v210
    v_permlane32_swap_b32 v209, v211
    s_waitcnt lgkmcnt(3)
    v_pk_add_f32 v[40:41], v[40:41], v[56:57]
    v_pk_add_f32 v[24:25], v[24:25], v[72:73]
    v_pk_add_f32 v[42:43], v[42:43], v[58:59]
    v_pk_add_f32 v[26:27], v[26:27], v[74:75]
    v_pk_add_f32 v[24:25], v[24:25], v[40:41]
    v_pk_add_f32 v[26:27], v[26:27], v[42:43]
    v_pk_mul_f32 v[40:41], v[24:25], v[184:185] op_sel:[0,0] op_sel_hi:[1,0]
    v_pk_mul_f32 v[42:43], v[26:27], v[184:185] op_sel:[0,0] op_sel_hi:[1,0]
    v_exp_f32 v40, v40
    v_exp_f32 v41, v41
    v_exp_f32 v42, v42
    v_exp_f32 v43, v43
    v_lshlrev_b32 v176, 16, v164
    v_and_b32 v177, 0xffff0000, v164
    v_lshlrev_b32 v178, 16, v165
    v_and_b32 v179, 0xffff0000, v165
    v_pk_add_f32 v[40:41], v[40:41], v[186:187] op_sel_hi:[1,0]
    v_pk_add_f32 v[42:43], v[42:43], v[186:187] op_sel_hi:[1,0]
    v_rcp_f32 v40, v40
    v_rcp_f32 v41, v41
    v_rcp_f32 v42, v42
    v_rcp_f32 v43, v43
    v_pk_mul_f32 v[24:25], v[24:25], v[40:41]
    v_pk_mul_f32 v[26:27], v[26:27], v[42:43]
    v_pk_fma_f32 v[24:25], v[24:25], v[176:177], v[144:145]
    v_pk_fma_f32 v[26:27], v[26:27], v[178:179], v[146:147]
    v_cvt_pk_bf16_f32 v212, v24, v25
    v_cvt_pk_bf16_f32 v213, v26, v27
    s_waitcnt lgkmcnt(0)
    v_pk_add_f32 v[44:45], v[44:45], v[60:61]
    v_pk_add_f32 v[28:29], v[28:29], v[76:77]
    v_pk_add_f32 v[46:47], v[46:47], v[62:63]
    v_pk_add_f32 v[30:31], v[30:31], v[78:79]
    v_pk_add_f32 v[28:29], v[28:29], v[44:45]
    v_pk_add_f32 v[30:31], v[30:31], v[46:47]
    v_pk_mul_f32 v[44:45], v[28:29], v[184:185] op_sel:[0,0] op_sel_hi:[1,0]
    v_pk_mul_f32 v[46:47], v[30:31], v[184:185] op_sel:[0,0] op_sel_hi:[1,0]
    v_exp_f32 v44, v44
    v_exp_f32 v45, v45
    v_exp_f32 v46, v46
    v_exp_f32 v47, v47
    v_lshlrev_b32 v180, 16, v166
    v_and_b32 v181, 0xffff0000, v166
    v_lshlrev_b32 v182, 16, v167
    v_and_b32 v183, 0xffff0000, v167
    v_pk_add_f32 v[44:45], v[44:45], v[186:187] op_sel_hi:[1,0]
    v_pk_add_f32 v[46:47], v[46:47], v[186:187] op_sel_hi:[1,0]
    v_rcp_f32 v44, v44
    v_rcp_f32 v45, v45
    v_rcp_f32 v46, v46
    v_rcp_f32 v47, v47
    v_pk_mul_f32 v[28:29], v[28:29], v[44:45]
    v_pk_mul_f32 v[30:31], v[30:31], v[46:47]
    v_pk_fma_f32 v[28:29], v[28:29], v[180:181], v[148:149]
    v_pk_fma_f32 v[30:31], v[30:31], v[182:183], v[150:151]
    v_cvt_pk_bf16_f32 v214, v28, v29
    v_cvt_pk_bf16_f32 v215, v30, v31
    s_nop 1
    v_permlane32_swap_b32 v212, v214
    v_permlane32_swap_b32 v213, v215
    s_nop 1
    v_permlane16_swap_b32 v208, v212
    v_permlane16_swap_b32 v209, v213
    v_permlane16_swap_b32 v210, v214
    v_permlane16_swap_b32 v211, v215
    buffer_store_dwordx4 v[208:211], v88, s[24:27], s60 offen sc0 sc1
    buffer_store_dwordx4 v[212:215], v88, s[24:27], s46 offen sc0 sc1
K_EXIT:
    s_endpgm
.section .rodata,"a"
.p2align 6
.amdhsa_kernel recurrent_scan__ssm_conv_s4d__mixer_channel_mlp__prompt_kernel
  .amdhsa_next_free_vgpr 256
  .amdhsa_next_free_sgpr 102
  .amdhsa_accum_offset 256
  .amdhsa_group_segment_fixed_size 0
  .amdhsa_kernarg_size 120
  .amdhsa_user_sgpr_count 2
  .amdhsa_user_sgpr_kernarg_segment_ptr 1
  .amdhsa_system_sgpr_workgroup_id_x 1
.end_amdhsa_kernel
```
